```python
import torch

def _softmax(x, axis=-1):
    return torch.softmax(x, dim=axis)

def _gelu(x):
    return torch.nn.functional.gelu(x, approximate='tanh')

def _silu(x):
    return torch.nn.functional.silu(x)

def _sigmoid(x):
    return torch.sigmoid(x)

def _layernorm(x, axis=-1, eps=1e-05):
    m = x.mean(dim=axis, keepdim=True)
    v = x.var(dim=axis, keepdim=True, unbiased=False)
    return (x - m) / torch.sqrt(v + eps)

def _scatter_add(tgt, idx, src, axis=0):
    return tgt.clone().index_add_(axis, idx, src)

def _segment_sum(src, seg, n):
    out = torch.zeros((n,) + src.shape[1:], dtype=src.dtype)
    return out.index_add_(0, seg, src)

def _pad(x, pw):
    flat = tuple((v for pair in reversed(pw) for v in pair))
    return torch.nn.functional.pad(x, flat)
kernel_name = 'adaLN_cond__linear_kernel_hedgehog__glu_gated_reglu__prompt'

def setup_inputs():

    _w = lambda a: (lambda t: t.to(torch.bfloat16) if t.is_floating_point() else t)(torch.as_tensor(a))

    def _A_setup():
        B, S, D, H = (1, 2048, 512, 32)
        Dh = D // H
        return {'x': _w((lambda *s: torch.randn(*s, dtype=torch.bfloat16) * 0.05)(B, S, D)), 'wqkv': _w((lambda *s: torch.randn(*s, dtype=torch.bfloat16) * 0.4)(D, 3 * D)), 'w_phi': _w((lambda *s: torch.randn(*s, dtype=torch.bfloat16) * 0.4)(H, Dh, Dh) * Dh ** (-0.5)), 'wo': _w((lambda *s: torch.randn(*s, dtype=torch.bfloat16) * 0.05)(D, D))}
    _A_in = _A_setup()

    def _B_setup():
        B, S, D, F = (1, 2048, 512, 1792)
        return {'x': _w((lambda *s: torch.randn(*s, dtype=torch.bfloat16) * 0.05)(B, S, D)), 'W_gate': _w((lambda *s: torch.randn(*s, dtype=torch.bfloat16) * 0.8)(D, F) * (2.0 / D) ** 0.5), 'W_up': _w((lambda *s: torch.randn(*s, dtype=torch.bfloat16) * 0.8)(D, F) * (2.0 / D) ** 0.5), 'W_down': _w((lambda *s: torch.randn(*s, dtype=torch.bfloat16) * 0.8)(F, D) * (1.0 / F) ** 0.5)}
    _B_in = _B_setup()
    return {'A_x': _A_in['x'], 'A_wqkv': _A_in['wqkv'], 'A_w_phi': _A_in['w_phi'], 'A_wo': _A_in['wo'], 'B_x': _B_in['x'], 'B_W_gate': _B_in['W_gate'], 'B_W_up': _B_in['W_up'], 'B_W_down': _B_in['W_down'], 'c': _w((lambda *s: torch.randn(*s, dtype=torch.bfloat16) * 0.2)(1, 512) * 8.0), 'w_mod': _w((lambda *s: torch.randn(*s, dtype=torch.bfloat16) * 0.2)(512, 6 * 512) * 512 ** (-0.5) * 8.0)}

def reference(A_x, A_wqkv, A_w_phi, A_wo, B_x, B_W_gate, B_W_up, B_W_down, c, w_mod):

    def _A_ref(x, wqkv, w_phi, wo):
        B, S, D = x.shape
        H = 32
        Dh = D // H
        qkv = (lambda x, *d: x.permute(*d))((x @ wqkv).reshape(B, S, 3, H, Dh), 2, 0, 3, 1, 4)
        q, k, v = (qkv[0], qkv[1], qkv[2])
        pq = torch.einsum('bhsd,hdf->bhsf', q, w_phi)
        pk = torch.einsum('bhsd,hdf->bhsf', k, w_phi)
        phi_q = torch.concatenate([_softmax(pq, axis=-1), _softmax(-pq, axis=-1)], axis=-1)
        phi_k = torch.concatenate([_softmax(pk, axis=-1), _softmax(-pk, axis=-1)], axis=-1)
        kv = torch.einsum('bhsf,bhsd->bhfd', phi_k, v)
        z = torch.einsum('bhsf->bhf', phi_k)
        num = torch.einsum('bhqf,bhfd->bhqd', phi_q, kv)
        den = torch.einsum('bhqf,bhf->bhq', phi_q, z)[..., None] + 1e-06
        o = num / den
        return (lambda x, *d: x.permute(*d))(o, 0, 2, 1, 3).reshape(B, S, D) @ wo

    def _B_ref(x, W_gate, W_up, W_down):
        gate = torch.einsum('bsd,df->bsf', x, W_gate)
        up = torch.einsum('bsd,df->bsf', x, W_up)
        gate = gate * (lambda x, dt: x.to(dt))(gate > 0, gate.dtype)
        h = gate * up
        return torch.einsum('bsf,fd->bsd', h, W_down)
    x = A_x
    mod = (_silu(c) @ w_mod).reshape(c.shape[0], 6, 1, -1)
    sa, ca, ga, sb, cb, gb = (mod[:, 0].clone(), mod[:, 1].clone(), mod[:, 2].clone(), mod[:, 3].clone(), mod[:, 4].clone(), mod[:, 5].clone())
    h = _layernorm(x, axis=-1) * (1 + ca) + sa
    x = x + ga * _A_ref(h, A_wqkv, A_w_phi, A_wo)
    h = _layernorm(x, axis=-1) * (1 + cb) + sb
    x = x + gb * _B_ref(h, B_W_gate, B_W_up, B_W_down)
    return x
```

```asm
; @launch grid=(256,1,1) block=(256,1,1) lds=153600
.amdgcn_target "amdgcn-amd-amdhsa--gfx950"
.text
.globl adaLN_cond__linear_kernel_hedgehog__glu_gated_reglu__prompt_kernel
.p2align 8
.type adaLN_cond__linear_kernel_hedgehog__glu_gated_reglu__prompt_kernel,@function
adaLN_cond__linear_kernel_hedgehog__glu_gated_reglu__prompt_kernel:
    s_cmp_ge_u32 s2, 256
    s_cbranch_scc1 adaLN_cond__linear_kernel_hedgehog__glu_gated_reglu__prompt_kernel_end
    s_load_dwordx16 s[4:19], s[0:1], 0
    s_load_dwordx8 s[20:27], s[0:1], 64
    s_load_dwordx2 s[28:29], s[0:1], 96
    v_lshrrev_b32 v1, 6, v0
    s_nop 0
    v_readfirstlane_b32 s30, v1
    v_and_b32 v1, 63, v0
    v_lshlrev_b32 v2, 4, v1
    s_waitcnt lgkmcnt(0)
    s_mov_b32 s32, s28
    s_and_b32 s33, s29, 0xffff
    s_mov_b32 s34, 25165824
    s_mov_b32 s35, 0x20000
    s_mov_b32 s56, s26
    s_and_b32 s57, s27, 0xffff
    s_mov_b32 s58, 256
    s_mov_b32 s59, 0x20000
    s_cmp_lg_u32 s2, 255
    s_cbranch_scc1 init_skip
    s_cmp_lg_u32 s30, 3
    s_cbranch_scc1 init_skip
    v_lshlrev_b32 v4, 8, v1
    v_mov_b32 v5, 0
    s_mov_b32 s60, 3932160
    buffer_store_dword v5, v4, s[32:35], s60 offen sc1
    s_mov_b32 s60, 3948544
    buffer_store_dword v5, v4, s[32:35], s60 offen sc1
    s_mov_b32 s60, 3964928
    buffer_store_dword v5, v4, s[32:35], s60 offen sc1
    s_mov_b32 s60, 3981312
    buffer_store_dword v5, v4, s[32:35], s60 offen sc1
    s_mov_b32 s60, 3997696
    buffer_store_dword v5, v4, s[32:35], s60 offen sc1
    v_mov_b32 v6, 0
    v_mov_b32 v8, 0
    v_mov_b32 v9, 0
    v_mov_b32 v10, 0
    v_mov_b32 v11, 0
    s_mov_b32 s60, 3670016
    buffer_store_dwordx4 v[8:11], v2, s[32:35], s60 offen offset:0 sc1
    buffer_store_dwordx4 v[8:11], v2, s[32:35], s60 offen offset:1024 sc1
    buffer_store_dwordx4 v[8:11], v2, s[32:35], s60 offen offset:2048 sc1
    buffer_store_dwordx4 v[8:11], v2, s[32:35], s60 offen offset:3072 sc1
    s_waitcnt vmcnt(0)
    v_mov_b32 v5, 1
    v_mov_b32 v4, 0
    s_mov_b64 exec, 1
    buffer_store_dword v5, v4, s[56:59], 0 offen sc1
    s_mov_b64 exec, -1
init_skip:
    s_cmp_lt_u32 s2, 48
    s_cbranch_scc1 p0_mod
    s_cmp_lt_u32 s2, 64
    s_cbranch_scc1 p0_misc
    s_cmp_lt_u32 s2, 192
    s_cbranch_scc1 p0_xh
    s_mov_b32 s48, s6
    s_and_b32 s49, s7, 0xffff
    s_mov_b32 s50, 1572864
    s_mov_b32 s51, 0x20000
    s_sub_u32 s52, s2, 192
    s_and_b32 s54, s52, 3
    s_lshr_b32 s53, s52, 2
    s_lshl_b32 s53, s53, 1
    s_lshr_b32 s55, s30, 1
    s_add_u32 s53, s53, s55
    s_and_b32 s56, s30, 1
    v_lshrrev_b32 v3, 3, v1
    v_and_b32 v4, 7, v1
    v_bfe_u32 v5, v3, 1, 1
    v_lshlrev_b32 v5, 2, v5
    v_xor_b32 v4, v4, v5
    v_mul_u32_u24 v3, 3072, v3
    v_lshl_add_u32 v3, v4, 4, v3
    s_mul_i32 s55, s53, 49152
    s_lshl_b32 s57, s54, 8
    s_add_u32 s55, s55, s57
    s_lshl_b32 s57, s56, 7
    s_add_u32 s55, s55, s57
    s_mul_i32 s57, s30, 6144
    s_add_u32 m0, s57, 0
    s_add_u32 s58, s55, 0
    buffer_load_dwordx4 v3, s[48:51], s58 offen nt lds
    s_add_u32 m0, s57, 1024
    s_add_u32 s58, s55, 24576
    buffer_load_dwordx4 v3, s[48:51], s58 offen nt lds
    s_add_u32 m0, s57, 2048
    s_add_u32 s58, s55, 1024
    buffer_load_dwordx4 v3, s[48:51], s58 offen nt lds
    s_add_u32 m0, s57, 3072
    s_add_u32 s58, s55, 25600
    buffer_load_dwordx4 v3, s[48:51], s58 offen nt lds
    s_add_u32 m0, s57, 4096
    s_add_u32 s58, s55, 2048
    buffer_load_dwordx4 v3, s[48:51], s58 offen nt lds
    s_add_u32 m0, s57, 5120
    s_add_u32 s58, s55, 26624
    buffer_load_dwordx4 v3, s[48:51], s58 offen nt lds
    s_getpc_b64 s[60:61]
pc_here0:
    s_sub_u32 s60, s60, pc_here0-adaLN_cond__linear_kernel_hedgehog__glu_gated_reglu__prompt_kernel
    s_subb_u32 s61, s61, 0
    s_lshr_b32 s62, s2, 3
    s_lshl_b32 s62, s62, 2
    s_add_u32 s62, s62, s30
    s_lshl_b32 s62, s62, 9
    v_lshlrev_b32 v252, 3, v1
    v_add_u32 v252, s62, v252
    v_min_u32 v252, code_end-adaLN_cond__linear_kernel_hedgehog__glu_gated_reglu__prompt_kernel-8, v252
    global_load_dwordx2 v[254:255], v252, s[60:61]
    v_bfe_u32 v5, v1, 2, 2
    v_lshrrev_b32 v6, 5, v1
    v_lshl_add_u32 v4, v6, 3, v5
    v_lshlrev_b32 v4, 7, v4
    v_lshrrev_b32 v5, 1, v5
    v_lshlrev_b32 v5, 2, v5
    v_bfe_u32 v6, v1, 4, 1
    v_lshlrev_b32 v6, 1, v6
    v_xor_b32 v5, v5, v6
    v_bfe_u32 v6, v1, 1, 1
    v_xor_b32 v5, v5, v6
    v_lshl_add_u32 v4, v5, 4, v4
    v_and_b32 v6, 1, v1
    v_lshl_add_u32 v4, v6, 3, v4
    v_add_u32 v4, s57, v4
    v_xor_b32 v5, 64, v4
    s_lshl_b32 s58, s54, 2
    s_lshl_b32 s59, s56, 1
    s_add_u32 s58, s58, s59
    s_lshl_b32 s58, s58, 5
    s_add_u32 s58, s58, s53
    s_mul_i32 s58, s58, 3072
    s_add_u32 s58, s58, 2097152
    s_add_u32 s59, s58, 98304
    s_waitcnt vmcnt(5)
    ds_read_b64_tr_b16 v[16:17], v4 offset:0
    ds_read_b64_tr_b16 v[18:19], v4 offset:512
    ds_read_b64_tr_b16 v[20:21], v5 offset:0
    ds_read_b64_tr_b16 v[22:23], v5 offset:512
    s_waitcnt vmcnt(3)
    ds_read_b64_tr_b16 v[24:25], v4 offset:2048
    ds_read_b64_tr_b16 v[26:27], v4 offset:2560
    ds_read_b64_tr_b16 v[28:29], v5 offset:2048
    ds_read_b64_tr_b16 v[30:31], v5 offset:2560
    s_waitcnt vmcnt(1)
    ds_read_b64_tr_b16 v[32:33], v4 offset:4096
    ds_read_b64_tr_b16 v[34:35], v4 offset:4608
    ds_read_b64_tr_b16 v[36:37], v5 offset:4096
    ds_read_b64_tr_b16 v[38:39], v5 offset:4608
    s_waitcnt lgkmcnt(10)
    buffer_store_dwordx4 v[16:19], v2, s[32:35], s58 offen offset:0 sc1
    s_waitcnt lgkmcnt(8)
    buffer_store_dwordx4 v[20:23], v2, s[32:35], s59 offen offset:0 sc1
    s_waitcnt lgkmcnt(6)
    buffer_store_dwordx4 v[24:27], v2, s[32:35], s58 offen offset:1024 sc1
    s_waitcnt lgkmcnt(4)
    buffer_store_dwordx4 v[28:31], v2, s[32:35], s59 offen offset:1024 sc1
    s_waitcnt lgkmcnt(2)
    buffer_store_dwordx4 v[32:35], v2, s[32:35], s58 offen offset:2048 sc1
    s_waitcnt lgkmcnt(0)
    buffer_store_dwordx4 v[36:39], v2, s[32:35], s59 offen offset:2048 sc1
    s_lshl_b32 s63, s54, 11
    s_add_u32 s63, s63, 3936256
    s_branch p0_done
p0_mod:
    s_mov_b32 s48, s20
    s_and_b32 s49, s21, 0xffff
    s_mov_b32 s50, 1024
    s_mov_b32 s51, 0x20000
    s_mov_b32 s52, s22
    s_and_b32 s53, s23, 0xffff
    s_mov_b32 s54, 3145728
    s_mov_b32 s55, 0x20000
    v_lshlrev_b32 v5, 2, v0
    buffer_load_dword v6, v5, s[48:51], 0 offen
    v_lshrrev_b32 v7, 3, v1
    v_and_b32 v8, 7, v1
    v_mul_u32_u24 v9, 6144, v7
    v_lshl_add_u32 v9, v8, 4, v9
    s_mul_i32 s56, s30, 786432
    s_lshl_b32 s57, s2, 7
    s_add_u32 s56, s56, s57
    buffer_load_dwordx4 v[48:51], v9, s[52:55], s56 offen nt
    s_add_u32 s56, s56, 49152
    buffer_load_dwordx4 v[52:55], v9, s[52:55], s56 offen nt
    s_add_u32 s56, s56, 49152
    buffer_load_dwordx4 v[56:59], v9, s[52:55], s56 offen nt
    s_add_u32 s56, s56, 49152
    buffer_load_dwordx4 v[60:63], v9, s[52:55], s56 offen nt
    s_add_u32 s56, s56, 49152
    buffer_load_dwordx4 v[64:67], v9, s[52:55], s56 offen nt
    s_add_u32 s56, s56, 49152
    buffer_load_dwordx4 v[68:71], v9, s[52:55], s56 offen nt
    s_add_u32 s56, s56, 49152
    buffer_load_dwordx4 v[72:75], v9, s[52:55], s56 offen nt
    s_add_u32 s56, s56, 49152
    buffer_load_dwordx4 v[76:79], v9, s[52:55], s56 offen nt
    s_add_u32 s56, s56, 49152
    buffer_load_dwordx4 v[80:83], v9, s[52:55], s56 offen nt
    s_add_u32 s56, s56, 49152
    buffer_load_dwordx4 v[84:87], v9, s[52:55], s56 offen nt
    s_add_u32 s56, s56, 49152
    buffer_load_dwordx4 v[88:91], v9, s[52:55], s56 offen nt
    s_add_u32 s56, s56, 49152
    buffer_load_dwordx4 v[92:95], v9, s[52:55], s56 offen nt
    s_add_u32 s56, s56, 49152
    buffer_load_dwordx4 v[96:99], v9, s[52:55], s56 offen nt
    s_add_u32 s56, s56, 49152
    buffer_load_dwordx4 v[100:103], v9, s[52:55], s56 offen nt
    s_add_u32 s56, s56, 49152
    buffer_load_dwordx4 v[104:107], v9, s[52:55], s56 offen nt
    s_add_u32 s56, s56, 49152
    buffer_load_dwordx4 v[108:111], v9, s[52:55], s56 offen nt
    s_getpc_b64 s[60:61]
pc_here1:
    s_sub_u32 s60, s60, pc_here1-adaLN_cond__linear_kernel_hedgehog__glu_gated_reglu__prompt_kernel
    s_subb_u32 s61, s61, 0
    s_lshr_b32 s62, s2, 3
    s_lshl_b32 s62, s62, 2
    s_add_u32 s62, s62, s30
    s_lshl_b32 s62, s62, 9
    v_lshlrev_b32 v252, 3, v1
    v_add_u32 v252, s62, v252
    v_min_u32 v252, code_end-adaLN_cond__linear_kernel_hedgehog__glu_gated_reglu__prompt_kernel-8, v252
    global_load_dwordx2 v[254:255], v252, s[60:61]
    v_lshrrev_b32 v10, 6, v0
    v_lshlrev_b32 v10, 7, v10
    v_lshlrev_b32 v11, 1, v0
    v_and_b32 v11, 7, v11
    v_lshl_add_u32 v10, v11, 4, v10
    v_lshrrev_b32 v11, 2, v0
    v_and_b32 v11, 15, v11
    v_add_lshl_u32 v10, v10, v11, 2
    v_add_u32 v10, 102400, v10
    s_waitcnt vmcnt(17)
    v_lshlrev_b32 v11, 16, v6
    v_and_b32 v12, 0xffff0000, v6
    v_mul_f32 v13, 0xbfb8aa3b, v11
    v_mul_f32 v14, 0xbfb8aa3b, v12
    v_exp_f32 v13, v13
    v_exp_f32 v14, v14
    v_add_f32 v13, 1.0, v13
    v_add_f32 v14, 1.0, v14
    v_rcp_f32 v13, v13
    v_rcp_f32 v14, v14
    v_mul_f32 v11, v11, v13
    v_mul_f32 v12, v12, v14
    v_cvt_pk_bf16_f32 v13, v11, v12
    v_lshlrev_b32 v11, 16, v13
    v_and_b32 v12, 0xffff0000, v13
    ds_write_b32 v10, v11
    ds_write_b32 v10, v12 offset:64
    s_waitcnt lgkmcnt(0)
    s_barrier
    s_mov_b32 s40, s26
    s_and_b32 s41, s27, 0xffff
    s_mov_b32 s42, 256
    s_mov_b32 s43, 0x20000
    v_mov_b32 v250, 0
    buffer_load_dword v251, v250, s[40:43], 0 offen sc1
    s_lshl_b32 s57, s30, 9
    s_add_u32 s57, s57, 102400
    v_lshlrev_b32 v10, 6, v7
    v_add_u32 v10, s57, v10
    ds_read_b128 v[16:19], v10 offset:0
    ds_read_b128 v[20:23], v10 offset:16
    ds_read_b128 v[24:27], v10 offset:32
    ds_read_b128 v[28:31], v10 offset:48
    v_mov_b32 v32, 0
    v_mov_b32 v33, 0
    v_mov_b32 v34, 0
    v_mov_b32 v35, 0
    v_mov_b32 v36, 0
    v_mov_b32 v37, 0
    v_mov_b32 v38, 0
    v_mov_b32 v39, 0
    s_waitcnt lgkmcnt(0)
    v_lshrrev_b32 v11, 16, v16
    s_waitcnt vmcnt(17)
    v_dot2c_f32_bf16 v32, v48, v11
    v_dot2c_f32_bf16 v33, v48, v16
    v_dot2c_f32_bf16 v34, v49, v11
    v_dot2c_f32_bf16 v35, v49, v16
    v_dot2c_f32_bf16 v36, v50, v11
    v_dot2c_f32_bf16 v37, v50, v16
    v_dot2c_f32_bf16 v38, v51, v11
    v_dot2c_f32_bf16 v39, v51, v16
    v_lshrrev_b32 v11, 16, v17
    s_waitcnt vmcnt(16)
    v_dot2c_f32_bf16 v32, v52, v11
    v_dot2c_f32_bf16 v33, v52, v17
    v_dot2c_f32_bf16 v34, v53, v11
    v_dot2c_f32_bf16 v35, v53, v17
    v_dot2c_f32_bf16 v36, v54, v11
    v_dot2c_f32_bf16 v37, v54, v17
    v_dot2c_f32_bf16 v38, v55, v11
    v_dot2c_f32_bf16 v39, v55, v17
    v_lshrrev_b32 v11, 16, v18
    s_waitcnt vmcnt(15)
    v_dot2c_f32_bf16 v32, v56, v11
    v_dot2c_f32_bf16 v33, v56, v18
    v_dot2c_f32_bf16 v34, v57, v11
    v_dot2c_f32_bf16 v35, v57, v18
    v_dot2c_f32_bf16 v36, v58, v11
    v_dot2c_f32_bf16 v37, v58, v18
    v_dot2c_f32_bf16 v38, v59, v11
    v_dot2c_f32_bf16 v39, v59, v18
    v_lshrrev_b32 v11, 16, v19
    s_waitcnt vmcnt(14)
    v_dot2c_f32_bf16 v32, v60, v11
    v_dot2c_f32_bf16 v33, v60, v19
    v_dot2c_f32_bf16 v34, v61, v11
    v_dot2c_f32_bf16 v35, v61, v19
    v_dot2c_f32_bf16 v36, v62, v11
    v_dot2c_f32_bf16 v37, v62, v19
    v_dot2c_f32_bf16 v38, v63, v11
    v_dot2c_f32_bf16 v39, v63, v19
    v_lshrrev_b32 v11, 16, v20
    s_waitcnt vmcnt(13)
    v_dot2c_f32_bf16 v32, v64, v11
    v_dot2c_f32_bf16 v33, v64, v20
    v_dot2c_f32_bf16 v34, v65, v11
    v_dot2c_f32_bf16 v35, v65, v20
    v_dot2c_f32_bf16 v36, v66, v11
    v_dot2c_f32_bf16 v37, v66, v20
    v_dot2c_f32_bf16 v38, v67, v11
    v_dot2c_f32_bf16 v39, v67, v20
    v_lshrrev_b32 v11, 16, v21
    s_waitcnt vmcnt(12)
    v_dot2c_f32_bf16 v32, v68, v11
    v_dot2c_f32_bf16 v33, v68, v21
    v_dot2c_f32_bf16 v34, v69, v11
    v_dot2c_f32_bf16 v35, v69, v21
    v_dot2c_f32_bf16 v36, v70, v11
    v_dot2c_f32_bf16 v37, v70, v21
    v_dot2c_f32_bf16 v38, v71, v11
    v_dot2c_f32_bf16 v39, v71, v21
    v_lshrrev_b32 v11, 16, v22
    s_waitcnt vmcnt(11)
    v_dot2c_f32_bf16 v32, v72, v11
    v_dot2c_f32_bf16 v33, v72, v22
    v_dot2c_f32_bf16 v34, v73, v11
    v_dot2c_f32_bf16 v35, v73, v22
    v_dot2c_f32_bf16 v36, v74, v11
    v_dot2c_f32_bf16 v37, v74, v22
    v_dot2c_f32_bf16 v38, v75, v11
    v_dot2c_f32_bf16 v39, v75, v22
    v_lshrrev_b32 v11, 16, v23
    s_waitcnt vmcnt(10)
    v_dot2c_f32_bf16 v32, v76, v11
    v_dot2c_f32_bf16 v33, v76, v23
    v_dot2c_f32_bf16 v34, v77, v11
    v_dot2c_f32_bf16 v35, v77, v23
    v_dot2c_f32_bf16 v36, v78, v11
    v_dot2c_f32_bf16 v37, v78, v23
    v_dot2c_f32_bf16 v38, v79, v11
    v_dot2c_f32_bf16 v39, v79, v23
    v_lshrrev_b32 v11, 16, v24
    s_waitcnt vmcnt(9)
    v_dot2c_f32_bf16 v32, v80, v11
    v_dot2c_f32_bf16 v33, v80, v24
    v_dot2c_f32_bf16 v34, v81, v11
    v_dot2c_f32_bf16 v35, v81, v24
    v_dot2c_f32_bf16 v36, v82, v11
    v_dot2c_f32_bf16 v37, v82, v24
    v_dot2c_f32_bf16 v38, v83, v11
    v_dot2c_f32_bf16 v39, v83, v24
    v_lshrrev_b32 v11, 16, v25
    s_waitcnt vmcnt(8)
    v_dot2c_f32_bf16 v32, v84, v11
    v_dot2c_f32_bf16 v33, v84, v25
    v_dot2c_f32_bf16 v34, v85, v11
    v_dot2c_f32_bf16 v35, v85, v25
    v_dot2c_f32_bf16 v36, v86, v11
    v_dot2c_f32_bf16 v37, v86, v25
    v_dot2c_f32_bf16 v38, v87, v11
    v_dot2c_f32_bf16 v39, v87, v25
    v_lshrrev_b32 v11, 16, v26
    s_waitcnt vmcnt(7)
    v_dot2c_f32_bf16 v32, v88, v11
    v_dot2c_f32_bf16 v33, v88, v26
    v_dot2c_f32_bf16 v34, v89, v11
    v_dot2c_f32_bf16 v35, v89, v26
    v_dot2c_f32_bf16 v36, v90, v11
    v_dot2c_f32_bf16 v37, v90, v26
    v_dot2c_f32_bf16 v38, v91, v11
    v_dot2c_f32_bf16 v39, v91, v26
    v_lshrrev_b32 v11, 16, v27
    s_waitcnt vmcnt(6)
    v_dot2c_f32_bf16 v32, v92, v11
    v_dot2c_f32_bf16 v33, v92, v27
    v_dot2c_f32_bf16 v34, v93, v11
    v_dot2c_f32_bf16 v35, v93, v27
    v_dot2c_f32_bf16 v36, v94, v11
    v_dot2c_f32_bf16 v37, v94, v27
    v_dot2c_f32_bf16 v38, v95, v11
    v_dot2c_f32_bf16 v39, v95, v27
    v_lshrrev_b32 v11, 16, v28
    s_waitcnt vmcnt(5)
    v_dot2c_f32_bf16 v32, v96, v11
    v_dot2c_f32_bf16 v33, v96, v28
    v_dot2c_f32_bf16 v34, v97, v11
    v_dot2c_f32_bf16 v35, v97, v28
    v_dot2c_f32_bf16 v36, v98, v11
    v_dot2c_f32_bf16 v37, v98, v28
    v_dot2c_f32_bf16 v38, v99, v11
    v_dot2c_f32_bf16 v39, v99, v28
    v_lshrrev_b32 v11, 16, v29
    s_waitcnt vmcnt(4)
    v_dot2c_f32_bf16 v32, v100, v11
    v_dot2c_f32_bf16 v33, v100, v29
    v_dot2c_f32_bf16 v34, v101, v11
    v_dot2c_f32_bf16 v35, v101, v29
    v_dot2c_f32_bf16 v36, v102, v11
    v_dot2c_f32_bf16 v37, v102, v29
    v_dot2c_f32_bf16 v38, v103, v11
    v_dot2c_f32_bf16 v39, v103, v29
    v_lshrrev_b32 v11, 16, v30
    s_waitcnt vmcnt(3)
    v_dot2c_f32_bf16 v32, v104, v11
    v_dot2c_f32_bf16 v33, v104, v30
    v_dot2c_f32_bf16 v34, v105, v11
    v_dot2c_f32_bf16 v35, v105, v30
    v_dot2c_f32_bf16 v36, v106, v11
    v_dot2c_f32_bf16 v37, v106, v30
    v_dot2c_f32_bf16 v38, v107, v11
    v_dot2c_f32_bf16 v39, v107, v30
    v_lshrrev_b32 v11, 16, v31
    s_waitcnt vmcnt(2)
    v_dot2c_f32_bf16 v32, v108, v11
    v_dot2c_f32_bf16 v33, v108, v31
    v_dot2c_f32_bf16 v34, v109, v11
    v_dot2c_f32_bf16 v35, v109, v31
    v_dot2c_f32_bf16 v36, v110, v11
    v_dot2c_f32_bf16 v37, v110, v31
    v_dot2c_f32_bf16 v38, v111, v11
    v_dot2c_f32_bf16 v39, v111, v31
    v_permlane32_swap_b32 v32, v36
    v_permlane32_swap_b32 v33, v37
    v_permlane32_swap_b32 v34, v38
    v_permlane32_swap_b32 v35, v39
    v_add_f32 v32, v32, v36
    v_add_f32 v33, v33, v37
    v_add_f32 v34, v34, v38
    v_add_f32 v35, v35, v39
    s_nop 0
    v_permlane16_swap_b32 v32, v34
    v_permlane16_swap_b32 v33, v35
    v_add_f32 v32, v32, v34
    v_add_f32 v33, v33, v35
    v_and_b32 v11, 8, v1
    v_cmp_ne_u32 vcc, 0, v11
    s_nop 1
    v_cndmask_b32 v12, v32, v33, vcc
    v_cndmask_b32 v13, v33, v32, vcc
    s_nop 1
    v_add_f32_dpp v12, v13, v12 row_ror:8 row_mask:0xf bank_mask:0xf
    v_lshlrev_b32 v13, 3, v8
    v_bfe_u32 v14, v1, 3, 1
    v_add_u32 v13, v13, v14
    v_bfe_u32 v14, v1, 4, 1
    v_lshl_add_u32 v13, v14, 1, v13
    v_bfe_u32 v14, v1, 5, 1
    v_lshl_add_u32 v13, v14, 2, v13
    s_lshl_b32 s57, s30, 8
    s_add_u32 s57, s57, 106496
    v_lshlrev_b32 v13, 2, v13
    v_add_u32 v13, s57, v13
    ds_write_b32 v13, v12
    s_waitcnt lgkmcnt(0)
    s_barrier
    s_cmp_lg_u32 s30, 0
    s_cbranch_scc1 p0_mod_tail
    v_lshlrev_b32 v10, 2, v1
    v_add_u32 v10, 106496, v10
    ds_read_b32 v12, v10 offset:0
    ds_read_b32 v13, v10 offset:256
    ds_read_b32 v14, v10 offset:512
    ds_read_b32 v15, v10 offset:768
    s_waitcnt lgkmcnt(0)
    v_add_f32 v12, v12, v13
    v_add_f32 v14, v14, v15
    v_add_f32 v12, v12, v14
    v_cvt_pk_bf16_f32 v12, v12, v12
    v_lshlrev_b32 v12, 16, v12
    s_lshr_b32 s57, s2, 3
    s_cmp_eq_u32 s57, 1
    s_cbranch_scc1 p0_mod_add1
    s_cmp_eq_u32 s57, 4
    s_cbranch_scc1 p0_mod_add1
    s_branch p0_mod_st
p0_mod_add1:
    v_add_f32 v12, 1.0, v12
    v_cvt_pk_bf16_f32 v12, v12, v12
    v_lshlrev_b32 v12, 16, v12
p0_mod_st:
    s_nop 1
    s_waitcnt vmcnt(0)
    v_readfirstlane_b32 s62, v251
    s_mov_b32 s61, 0
    s_nop 3
    s_nop 3
p0rdy_chk:
    s_cmp_eq_u32 s62, 1
    s_cbranch_scc1 p0rdy_ok
    buffer_load_dword v251, v250, s[40:43], 0 offen sc1
    s_add_u32 s61, s61, 1
    s_waitcnt vmcnt(0)
    v_readfirstlane_b32 s62, v251
    s_nop 3
    s_cmp_lt_u32 s61, 400000
    s_cbranch_scc1 p0rdy_chk
p0rdy_ok:
    s_cmp_ge_u32 s2, 16
    s_cbranch_scc1 p0_mod_plain
    v_or_b32 v16, 1, v12
    s_lshl_b32 s58, s2, 6
    v_add_u32 v13, s58, v1
    v_lshlrev_b32 v14, 2, v13
    s_mov_b32 s59, 3670016
    buffer_store_dword v16, v14, s[32:35], s59 offen sc1
    s_branch p0_mod_tail
p0_mod_plain:
    s_lshl_b32 s58, s2, 6
    v_add_u32 v13, s58, v1
    v_lshlrev_b32 v14, 2, v13
    s_mov_b32 s59, 3670016
    buffer_store_dword v12, v14, s[32:35], s59 offen sc1
    v_lshrrev_b32 v15, 16, v12
    v_lshlrev_b32 v14, 1, v13
    s_mov_b32 s59, 3686400
    buffer_store_short v15, v14, s[32:35], s59 offen sc1
p0_mod_tail:
    s_lshr_b32 s63, s2, 4
    s_lshl_b32 s63, s63, 11
    s_add_u32 s63, s63, 3944448
    s_branch p0_done
p0_misc:
    s_mov_b32 s48, s8
    s_and_b32 s49, s9, 0xffff
    s_mov_b32 s50, 16384
    s_mov_b32 s51, 0x20000
    s_getpc_b64 s[60:61]
pc_here2:
    s_sub_u32 s60, s60, pc_here2-adaLN_cond__linear_kernel_hedgehog__glu_gated_reglu__prompt_kernel
    s_subb_u32 s61, s61, 0
    s_lshr_b32 s62, s2, 3
    s_lshl_b32 s62, s62, 2
    s_add_u32 s62, s62, s30
    s_lshl_b32 s62, s62, 9
    v_lshlrev_b32 v252, 3, v1
    v_add_u32 v252, s62, v252
    v_min_u32 v252, code_end-adaLN_cond__linear_kernel_hedgehog__glu_gated_reglu__prompt_kernel-8, v252
    global_load_dwordx2 v[254:255], v252, s[60:61]
    s_sub_u32 s56, s2, 48
    v_mov_b32 v8, 0
    v_mov_b32 v9, 0
    v_mov_b32 v10, 0
    v_mov_b32 v11, 0
    v_lshlrev_b32 v5, 4, v0
    s_lshl_b32 s57, s56, 13
    s_add_u32 s57, s57, 3801088
    buffer_store_dwordx4 v[8:11], v5, s[32:35], s57 offen sc1
    s_add_u32 s57, s57, 4096
    buffer_store_dwordx4 v[8:11], v5, s[32:35], s57 offen sc1
    s_cmp_ge_u32 s30, 2
    s_cbranch_scc1 p0_misc_tail
    s_lshl_b32 s58, s56, 1
    s_add_u32 s58, s58, s30
    v_and_b32 v12, 31, v1
    v_lshrrev_b32 v13, 5, v1
    v_lshrrev_b32 v14, 3, v12
    v_and_b32 v15, 3, v12
    v_lshl_add_u32 v14, v14, 2, v15
    v_lshlrev_b32 v16, 6, v13
    v_add_lshl_u32 v16, v16, v14, 1
    s_lshl_b32 s59, s58, 9
    buffer_load_ushort v24, v16, s[48:51], s59 offen offset:0
    buffer_load_ushort v25, v16, s[48:51], s59 offen offset:32
    buffer_load_ushort v26, v16, s[48:51], s59 offen offset:64
    buffer_load_ushort v27, v16, s[48:51], s59 offen offset:96
    buffer_load_ushort v28, v16, s[48:51], s59 offen offset:256
    buffer_load_ushort v29, v16, s[48:51], s59 offen offset:288
    buffer_load_ushort v30, v16, s[48:51], s59 offen offset:320
    buffer_load_ushort v31, v16, s[48:51], s59 offen offset:352
    v_bfe_u32 v17, v12, 2, 1
    v_mul_u32_u24 v17, 0x8000, v17
    v_lshl_or_b32 v17, v17, 16, v17
    s_waitcnt vmcnt(0)
    v_lshl_or_b32 v32, v25, 16, v24
    v_xor_b32 v32, v32, v17
    v_lshl_or_b32 v33, v27, 16, v26
    v_xor_b32 v33, v33, v17
    v_lshl_or_b32 v34, v29, 16, v28
    v_xor_b32 v34, v34, v17
    v_lshl_or_b32 v35, v31, 16, v30
    v_xor_b32 v35, v35, v17
    v_lshlrev_b32 v18, 4, v1
    s_lshl_b32 s59, s58, 10
    s_add_u32 s59, s59, 3735552
    buffer_store_dwordx4 v[32:35], v18, s[32:35], s59 offen sc1
p0_misc_tail:
    s_nop 1
    s_mov_b32 s63, 3950592
    s_branch p0_done
p0_xh:
    s_mov_b32 s48, s4
    s_and_b32 s49, s5, 0xffff
    s_mov_b32 s50, 2097152
    s_mov_b32 s51, 0x20000
    s_sub_u32 s56, s2, 64
    s_lshl_b32 s57, s56, 4
    s_lshl_b32 s58, s30, 2
    s_add_u32 s57, s57, s58
    s_lshl_b32 s58, s57, 10
    buffer_load_dwordx4 v[8:11], v2, s[48:51], s58 offen offset:0
    buffer_load_dwordx4 v[12:15], v2, s[48:51], s58 offen offset:1024
    buffer_load_dwordx4 v[16:19], v2, s[48:51], s58 offen offset:2048
    buffer_load_dwordx4 v[20:23], v2, s[48:51], s58 offen offset:3072
    s_getpc_b64 s[60:61]
pc_here3:
    s_sub_u32 s60, s60, pc_here3-adaLN_cond__linear_kernel_hedgehog__glu_gated_reglu__prompt_kernel
    s_subb_u32 s61, s61, 0
    s_lshr_b32 s62, s2, 3
    s_lshl_b32 s62, s62, 2
    s_add_u32 s62, s62, s30
    s_lshl_b32 s62, s62, 9
    v_lshlrev_b32 v252, 3, v1
    v_add_u32 v252, s62, v252
    v_min_u32 v252, code_end-adaLN_cond__linear_kernel_hedgehog__glu_gated_reglu__prompt_kernel-8, v252
    global_load_dwordx2 v[254:255], v252, s[60:61]
    s_lshl_b32 s53, s56, 4
    s_lshr_b32 s59, s53, 5
    s_lshl_b32 s59, s59, 15
    s_and_b32 s58, s53, 31
    s_lshl_b32 s58, s58, 4
    s_add_u32 s59, s59, s58
    s_lshl_b32 s58, s30, 13
    s_add_u32 s59, s59, s58
    v_lshrrev_b32 v5, 4, v1
    v_and_b32 v6, 15, v1
    v_lshlrev_b32 v7, 9, v5
    v_lshl_add_u32 v7, v6, 4, v7
    s_lshl_b32 s58, s30, 4
    v_add_u32 v5, s58, v5
    s_waitcnt vmcnt(4)
    v_lshlrev_b32 v32, 16, v8
    v_and_b32 v33, 0xffff0000, v8
    v_lshlrev_b32 v34, 16, v9
    v_and_b32 v35, 0xffff0000, v9
    v_lshlrev_b32 v36, 16, v10
    v_and_b32 v37, 0xffff0000, v10
    v_lshlrev_b32 v38, 16, v11
    v_and_b32 v39, 0xffff0000, v11
    s_waitcnt vmcnt(3)
    v_lshlrev_b32 v40, 16, v12
    v_and_b32 v41, 0xffff0000, v12
    v_lshlrev_b32 v42, 16, v13
    v_and_b32 v43, 0xffff0000, v13
    v_lshlrev_b32 v44, 16, v14
    v_and_b32 v45, 0xffff0000, v14
    v_lshlrev_b32 v46, 16, v15
    v_and_b32 v47, 0xffff0000, v15
    s_waitcnt vmcnt(2)
    v_lshlrev_b32 v48, 16, v16
    v_and_b32 v49, 0xffff0000, v16
    v_lshlrev_b32 v50, 16, v17
    v_and_b32 v51, 0xffff0000, v17
    v_lshlrev_b32 v52, 16, v18
    v_and_b32 v53, 0xffff0000, v18
    v_lshlrev_b32 v54, 16, v19
    v_and_b32 v55, 0xffff0000, v19
    s_waitcnt vmcnt(1)
    v_lshlrev_b32 v56, 16, v20
    v_and_b32 v57, 0xffff0000, v20
    v_lshlrev_b32 v58, 16, v21
    v_and_b32 v59, 0xffff0000, v21
    v_lshlrev_b32 v60, 16, v22
    v_and_b32 v61, 0xffff0000, v22
    v_lshlrev_b32 v62, 16, v23
    v_and_b32 v63, 0xffff0000, v23
    v_pk_add_f32 v[64:65], v[32:33], v[34:35]
    v_pk_mul_f32 v[76:77], v[32:33], v[32:33]
    v_pk_add_f32 v[66:67], v[40:41], v[42:43]
    v_pk_mul_f32 v[78:79], v[40:41], v[40:41]
    v_pk_add_f32 v[68:69], v[48:49], v[50:51]
    v_pk_mul_f32 v[80:81], v[48:49], v[48:49]
    v_pk_add_f32 v[70:71], v[56:57], v[58:59]
    v_pk_mul_f32 v[82:83], v[56:57], v[56:57]
    v_pk_add_f32 v[64:65], v[64:65], v[36:37]
    v_pk_add_f32 v[66:67], v[66:67], v[44:45]
    v_pk_add_f32 v[68:69], v[68:69], v[52:53]
    v_pk_add_f32 v[70:71], v[70:71], v[60:61]
    v_pk_add_f32 v[64:65], v[64:65], v[38:39]
    v_pk_add_f32 v[66:67], v[66:67], v[46:47]
    v_pk_add_f32 v[68:69], v[68:69], v[54:55]
    v_pk_add_f32 v[70:71], v[70:71], v[62:63]
    v_pk_fma_f32 v[76:77], v[34:35], v[34:35], v[76:77]
    v_pk_fma_f32 v[78:79], v[42:43], v[42:43], v[78:79]
    v_pk_fma_f32 v[80:81], v[50:51], v[50:51], v[80:81]
    v_pk_fma_f32 v[82:83], v[58:59], v[58:59], v[82:83]
    v_pk_fma_f32 v[76:77], v[36:37], v[36:37], v[76:77]
    v_pk_fma_f32 v[78:79], v[44:45], v[44:45], v[78:79]
    v_pk_fma_f32 v[80:81], v[52:53], v[52:53], v[80:81]
    v_pk_fma_f32 v[82:83], v[60:61], v[60:61], v[82:83]
    v_pk_fma_f32 v[76:77], v[38:39], v[38:39], v[76:77]
    v_pk_fma_f32 v[78:79], v[46:47], v[46:47], v[78:79]
    v_pk_fma_f32 v[80:81], v[54:55], v[54:55], v[80:81]
    v_pk_fma_f32 v[82:83], v[62:63], v[62:63], v[82:83]
    v_add_f32 v24, v64, v65
    v_add_f32 v28, v76, v77
    v_add_f32 v25, v66, v67
    v_add_f32 v29, v78, v79
    v_add_f32 v26, v68, v69
    v_add_f32 v30, v80, v81
    v_add_f32 v27, v70, v71
    v_add_f32 v31, v82, v83
    v_add_f32_dpp v24, v24, v24 row_ror:8 row_mask:0xf bank_mask:0xf
    v_add_f32_dpp v25, v25, v25 row_ror:8 row_mask:0xf bank_mask:0xf
    v_add_f32_dpp v26, v26, v26 row_ror:8 row_mask:0xf bank_mask:0xf
    v_add_f32_dpp v27, v27, v27 row_ror:8 row_mask:0xf bank_mask:0xf
    v_add_f32_dpp v28, v28, v28 row_ror:8 row_mask:0xf bank_mask:0xf
    v_add_f32_dpp v29, v29, v29 row_ror:8 row_mask:0xf bank_mask:0xf
    v_add_f32_dpp v30, v30, v30 row_ror:8 row_mask:0xf bank_mask:0xf
    v_add_f32_dpp v31, v31, v31 row_ror:8 row_mask:0xf bank_mask:0xf
    v_add_f32_dpp v24, v24, v24 row_ror:4 row_mask:0xf bank_mask:0xf
    v_add_f32_dpp v25, v25, v25 row_ror:4 row_mask:0xf bank_mask:0xf
    v_add_f32_dpp v26, v26, v26 row_ror:4 row_mask:0xf bank_mask:0xf
    v_add_f32_dpp v27, v27, v27 row_ror:4 row_mask:0xf bank_mask:0xf
    v_add_f32_dpp v28, v28, v28 row_ror:4 row_mask:0xf bank_mask:0xf
    v_add_f32_dpp v29, v29, v29 row_ror:4 row_mask:0xf bank_mask:0xf
    v_add_f32_dpp v30, v30, v30 row_ror:4 row_mask:0xf bank_mask:0xf
    v_add_f32_dpp v31, v31, v31 row_ror:4 row_mask:0xf bank_mask:0xf
    v_add_f32_dpp v24, v24, v24 row_ror:2 row_mask:0xf bank_mask:0xf
    v_add_f32_dpp v25, v25, v25 row_ror:2 row_mask:0xf bank_mask:0xf
    v_add_f32_dpp v26, v26, v26 row_ror:2 row_mask:0xf bank_mask:0xf
    v_add_f32_dpp v27, v27, v27 row_ror:2 row_mask:0xf bank_mask:0xf
    v_add_f32_dpp v28, v28, v28 row_ror:2 row_mask:0xf bank_mask:0xf
    v_add_f32_dpp v29, v29, v29 row_ror:2 row_mask:0xf bank_mask:0xf
    v_add_f32_dpp v30, v30, v30 row_ror:2 row_mask:0xf bank_mask:0xf
    v_add_f32_dpp v31, v31, v31 row_ror:2 row_mask:0xf bank_mask:0xf
    v_add_f32_dpp v24, v24, v24 row_ror:1 row_mask:0xf bank_mask:0xf
    v_add_f32_dpp v25, v25, v25 row_ror:1 row_mask:0xf bank_mask:0xf
    v_add_f32_dpp v26, v26, v26 row_ror:1 row_mask:0xf bank_mask:0xf
    v_add_f32_dpp v27, v27, v27 row_ror:1 row_mask:0xf bank_mask:0xf
    v_add_f32_dpp v28, v28, v28 row_ror:1 row_mask:0xf bank_mask:0xf
    v_add_f32_dpp v29, v29, v29 row_ror:1 row_mask:0xf bank_mask:0xf
    v_add_f32_dpp v30, v30, v30 row_ror:1 row_mask:0xf bank_mask:0xf
    v_add_f32_dpp v31, v31, v31 row_ror:1 row_mask:0xf bank_mask:0xf
    v_add_f32_dpp v24, v24, v24 row_bcast:15 row_mask:0xa bank_mask:0xf
    v_add_f32_dpp v25, v25, v25 row_bcast:15 row_mask:0xa bank_mask:0xf
    v_add_f32_dpp v26, v26, v26 row_bcast:15 row_mask:0xa bank_mask:0xf
    v_add_f32_dpp v27, v27, v27 row_bcast:15 row_mask:0xa bank_mask:0xf
    v_add_f32_dpp v28, v28, v28 row_bcast:15 row_mask:0xa bank_mask:0xf
    v_add_f32_dpp v29, v29, v29 row_bcast:15 row_mask:0xa bank_mask:0xf
    v_add_f32_dpp v30, v30, v30 row_bcast:15 row_mask:0xa bank_mask:0xf
    v_add_f32_dpp v31, v31, v31 row_bcast:15 row_mask:0xa bank_mask:0xf
    v_add_f32_dpp v24, v24, v24 row_bcast:31 row_mask:0xc bank_mask:0xf
    v_add_f32_dpp v25, v25, v25 row_bcast:31 row_mask:0xc bank_mask:0xf
    v_add_f32_dpp v26, v26, v26 row_bcast:31 row_mask:0xc bank_mask:0xf
    v_add_f32_dpp v27, v27, v27 row_bcast:31 row_mask:0xc bank_mask:0xf
    v_add_f32_dpp v28, v28, v28 row_bcast:31 row_mask:0xc bank_mask:0xf
    v_add_f32_dpp v29, v29, v29 row_bcast:31 row_mask:0xc bank_mask:0xf
    v_add_f32_dpp v30, v30, v30 row_bcast:31 row_mask:0xc bank_mask:0xf
    v_add_f32_dpp v31, v31, v31 row_bcast:31 row_mask:0xc bank_mask:0xf
    v_readlane_b32 s48, v24, 63
    v_readlane_b32 s52, v28, 63
    v_readlane_b32 s49, v25, 63
    v_readlane_b32 s53, v29, 63
    v_readlane_b32 s50, v26, 63
    v_readlane_b32 s54, v30, 63
    v_readlane_b32 s51, v27, 63
    v_readlane_b32 s55, v31, 63
    s_mov_b32 s58, 0x3b000000
    v_mov_b32 v73, 0x3727c5ac
    v_mov_b32 v64, s48
    v_mov_b32 v76, s52
    v_mov_b32 v66, s49
    v_mov_b32 v78, s53
    v_mov_b32 v68, s50
    v_mov_b32 v80, s54
    v_mov_b32 v70, s51
    v_mov_b32 v82, s55
    v_mul_f32 v64, s58, v64
    v_fma_f32 v76, v76, s58, v73
    v_mul_f32 v66, s58, v66
    v_fma_f32 v78, v78, s58, v73
    v_mul_f32 v68, s58, v68
    v_fma_f32 v80, v80, s58, v73
    v_mul_f32 v70, s58, v70
    v_fma_f32 v82, v82, s58, v73
    v_fma_f32 v76, -v64, v64, v76
    v_max_f32 v76, v76, v73
    v_fma_f32 v78, -v66, v66, v78
    v_max_f32 v78, v78, v73
    v_fma_f32 v80, -v68, v68, v80
    v_max_f32 v80, v80, v73
    v_fma_f32 v82, -v70, v70, v82
    v_max_f32 v82, v82, v73
    v_rsq_f32 v76, v76
    v_rsq_f32 v78, v78
    v_rsq_f32 v80, v80
    v_rsq_f32 v82, v82
    v_mul_f32 v64, v64, v76
    v_sub_f32 v64, 0, v64
    v_mul_f32 v66, v66, v78
    v_sub_f32 v66, 0, v66
    v_mul_f32 v68, v68, v80
    v_sub_f32 v68, 0, v68
    v_mul_f32 v70, v70, v82
    v_sub_f32 v70, 0, v70
    v_pk_fma_f32 v[32:33], v[32:33], v[76:77], v[64:65] op_sel_hi:[1,0,0]
    v_pk_fma_f32 v[34:35], v[34:35], v[76:77], v[64:65] op_sel_hi:[1,0,0]
    v_pk_fma_f32 v[36:37], v[36:37], v[76:77], v[64:65] op_sel_hi:[1,0,0]
    v_pk_fma_f32 v[38:39], v[38:39], v[76:77], v[64:65] op_sel_hi:[1,0,0]
    v_pk_fma_f32 v[40:41], v[40:41], v[78:79], v[66:67] op_sel_hi:[1,0,0]
    v_pk_fma_f32 v[42:43], v[42:43], v[78:79], v[66:67] op_sel_hi:[1,0,0]
    v_pk_fma_f32 v[44:45], v[44:45], v[78:79], v[66:67] op_sel_hi:[1,0,0]
    v_pk_fma_f32 v[46:47], v[46:47], v[78:79], v[66:67] op_sel_hi:[1,0,0]
    v_pk_fma_f32 v[48:49], v[48:49], v[80:81], v[68:69] op_sel_hi:[1,0,0]
    v_pk_fma_f32 v[50:51], v[50:51], v[80:81], v[68:69] op_sel_hi:[1,0,0]
    v_pk_fma_f32 v[52:53], v[52:53], v[80:81], v[68:69] op_sel_hi:[1,0,0]
    v_pk_fma_f32 v[54:55], v[54:55], v[80:81], v[68:69] op_sel_hi:[1,0,0]
    v_pk_fma_f32 v[56:57], v[56:57], v[82:83], v[70:71] op_sel_hi:[1,0,0]
    v_pk_fma_f32 v[58:59], v[58:59], v[82:83], v[70:71] op_sel_hi:[1,0,0]
    v_pk_fma_f32 v[60:61], v[60:61], v[82:83], v[70:71] op_sel_hi:[1,0,0]
    v_pk_fma_f32 v[62:63], v[62:63], v[82:83], v[70:71] op_sel_hi:[1,0,0]
    v_cvt_pk_bf16_f32 v8, v32, v33
    v_cvt_pk_bf16_f32 v9, v34, v35
    v_cvt_pk_bf16_f32 v10, v36, v37
    v_cvt_pk_bf16_f32 v11, v38, v39
    s_lshl_b32 s58, s30, 2
    s_add_u32 s58, s58, 0
    v_xor_b32 v72, s58, v1
    v_lshlrev_b32 v72, 4, v72
    s_lshl_b32 s58, s58, 10
    s_add_u32 s58, s58, 102400
    v_add_u32 v72, s58, v72
    ds_write_b128 v72, v[8:11]
    v_cvt_pk_bf16_f32 v12, v40, v41
    v_cvt_pk_bf16_f32 v13, v42, v43
    v_cvt_pk_bf16_f32 v14, v44, v45
    v_cvt_pk_bf16_f32 v15, v46, v47
    s_lshl_b32 s58, s30, 2
    s_add_u32 s58, s58, 1
    v_xor_b32 v72, s58, v1
    v_lshlrev_b32 v72, 4, v72
    s_lshl_b32 s58, s58, 10
    s_add_u32 s58, s58, 102400
    v_add_u32 v72, s58, v72
    ds_write_b128 v72, v[12:15]
    v_cvt_pk_bf16_f32 v16, v48, v49
    v_cvt_pk_bf16_f32 v17, v50, v51
    v_cvt_pk_bf16_f32 v18, v52, v53
    v_cvt_pk_bf16_f32 v19, v54, v55
    s_lshl_b32 s58, s30, 2
    s_add_u32 s58, s58, 2
    v_xor_b32 v72, s58, v1
    v_lshlrev_b32 v72, 4, v72
    s_lshl_b32 s58, s58, 10
    s_add_u32 s58, s58, 102400
    v_add_u32 v72, s58, v72
    ds_write_b128 v72, v[16:19]
    v_cvt_pk_bf16_f32 v20, v56, v57
    v_cvt_pk_bf16_f32 v21, v58, v59
    v_cvt_pk_bf16_f32 v22, v60, v61
    v_cvt_pk_bf16_f32 v23, v62, v63
    s_lshl_b32 s58, s30, 2
    s_add_u32 s58, s58, 3
    v_xor_b32 v72, s58, v1
    v_lshlrev_b32 v72, 4, v72
    s_lshl_b32 s58, s58, 10
    s_add_u32 s58, s58, 102400
    v_add_u32 v72, s58, v72
    ds_write_b128 v72, v[20:23]
    s_waitcnt lgkmcnt(0)
    s_barrier
    v_add_u32 v72, 0, v5
    v_xor_b32 v72, v72, v6
    v_lshlrev_b32 v72, 4, v72
    v_lshl_add_u32 v72, v6, 10, v72
    v_add_u32 v72, 102400, v72
    ds_read_b128 v[8:11], v72
    v_add_u32 v72, 4, v5
    v_xor_b32 v72, v72, v6
    v_lshlrev_b32 v72, 4, v72
    v_lshl_add_u32 v72, v6, 10, v72
    v_add_u32 v72, 102400, v72
    ds_read_b128 v[12:15], v72
    v_add_u32 v72, 8, v5
    v_xor_b32 v72, v72, v6
    v_lshlrev_b32 v72, 4, v72
    v_lshl_add_u32 v72, v6, 10, v72
    v_add_u32 v72, 102400, v72
    ds_read_b128 v[16:19], v72
    v_add_u32 v72, 12, v5
    v_xor_b32 v72, v72, v6
    v_lshlrev_b32 v72, 4, v72
    v_lshl_add_u32 v72, v6, 10, v72
    v_add_u32 v72, 102400, v72
    ds_read_b128 v[20:23], v72
    s_waitcnt lgkmcnt(3)
    buffer_store_dwordx4 v[8:11], v7, s[32:35], s59 offen offset:0 sc1
    s_waitcnt lgkmcnt(2)
    buffer_store_dwordx4 v[12:15], v7, s[32:35], s59 offen offset:2048 sc1
    s_waitcnt lgkmcnt(1)
    s_add_u32 s59, s59, 4096
    buffer_store_dwordx4 v[16:19], v7, s[32:35], s59 offen offset:0 sc1
    s_waitcnt lgkmcnt(0)
    buffer_store_dwordx4 v[20:23], v7, s[32:35], s59 offen offset:2048 sc1
    s_lshr_b32 s63, s56, 3
    s_lshl_b32 s63, s63, 8
    s_add_u32 s63, s63, 3932160
p0_done:
    s_mov_b32 s56, s26
    s_and_b32 s57, s27, 0xffff
    s_mov_b32 s58, 256
    s_mov_b32 s59, 0x20000
    s_cmp_lt_u32 s2, 48
    s_cbranch_scc1 rdy_w
    s_cmp_lg_u32 s30, 0
    s_cbranch_scc1 rdy_w
    v_mov_b32 v10, 0
    s_mov_b32 s61, 0
rdy_poll:
    buffer_load_dword v11, v10, s[56:59], 0 offen sc1
    s_waitcnt vmcnt(0)
    v_readfirstlane_b32 s62, v11
    s_add_u32 s61, s61, 1
    s_nop 2
    s_cmp_eq_u32 s62, 1
    s_cbranch_scc1 rdy_w
    s_cmp_lt_u32 s61, 400000
    s_cbranch_scc1 rdy_poll
rdy_w:
    s_cmp_ge_u32 s2, 48
    s_cbranch_scc1 s0a_drain
    s_barrier
    s_branch s0a_done
s0a_drain:
    s_waitcnt vmcnt(0) lgkmcnt(0)
    s_barrier
    s_cmp_lt_u32 s2, 64
    s_cbranch_scc1 s0a_rep
    s_cmp_ge_u32 s2, 192
    s_cbranch_scc1 s0a_rep
    s_cmp_lg_u32 s30, 0
    s_cbranch_scc1 s0a_done
    v_mov_b32 v10, 0
    v_mov_b32 v11, 1
    s_mov_b64 exec, 1
    buffer_atomic_add v11, v10, s[32:35], s63 offen
    s_mov_b64 exec, -1
    s_branch s0a_done
s0a_rep:
    s_cmp_lg_u32 s30, 0
    s_cbranch_scc1 s0r_skip
    v_lshlrev_b32 v10, 8, v1
    v_mov_b32 v11, 1
    s_mov_b64 exec, 0xff
    buffer_atomic_add v11, v10, s[32:35], s63 offen
    s_mov_b64 exec, -1
s0r_skip:
s0a_done:
code_p1:
    v_mov_b32 v184, 0x3f803f80
    v_mov_b32 v185, 0x3f803f80
    v_mov_b32 v186, 0x3f803f80
    v_mov_b32 v187, 0x3f803f80
    v_and_b32 v3, 31, v1
    v_lshrrev_b32 v4, 5, v1
    v_lshlrev_b32 v8, 4, v4
    v_sub_u32 v8, v3, v8
    v_mov_b32 v5, 0x3f80
    v_mov_b32 v6, 0x3f800000
    v_cmp_eq_u32 vcc, 0, v8
    s_nop 1
    v_cndmask_b32 v176, 0, v5, vcc
    v_cmp_eq_u32 vcc, 1, v8
    s_nop 1
    v_cndmask_b32 v176, v176, v6, vcc
    v_cmp_eq_u32 vcc, 2, v8
    s_nop 1
    v_cndmask_b32 v177, 0, v5, vcc
    v_cmp_eq_u32 vcc, 3, v8
    s_nop 1
    v_cndmask_b32 v177, v177, v6, vcc
    v_cmp_eq_u32 vcc, 4, v8
    s_nop 1
    v_cndmask_b32 v178, 0, v5, vcc
    v_cmp_eq_u32 vcc, 5, v8
    s_nop 1
    v_cndmask_b32 v178, v178, v6, vcc
    v_cmp_eq_u32 vcc, 6, v8
    s_nop 1
    v_cndmask_b32 v179, 0, v5, vcc
    v_cmp_eq_u32 vcc, 7, v8
    s_nop 1
    v_cndmask_b32 v179, v179, v6, vcc
    v_cmp_eq_u32 vcc, 8, v8
    s_nop 1
    v_cndmask_b32 v180, 0, v5, vcc
    v_cmp_eq_u32 vcc, 9, v8
    s_nop 1
    v_cndmask_b32 v180, v180, v6, vcc
    v_cmp_eq_u32 vcc, 10, v8
    s_nop 1
    v_cndmask_b32 v181, 0, v5, vcc
    v_cmp_eq_u32 vcc, 11, v8
    s_nop 1
    v_cndmask_b32 v181, v181, v6, vcc
    v_cmp_eq_u32 vcc, 12, v8
    s_nop 1
    v_cndmask_b32 v182, 0, v5, vcc
    v_cmp_eq_u32 vcc, 13, v8
    s_nop 1
    v_cndmask_b32 v182, v182, v6, vcc
    v_cmp_eq_u32 vcc, 14, v8
    s_nop 1
    v_cndmask_b32 v183, 0, v5, vcc
    v_cmp_eq_u32 vcc, 15, v8
    s_nop 1
    v_cndmask_b32 v183, v183, v6, vcc
    v_lshrrev_b32 v8, 3, v3
    v_and_b32 v9, 3, v3
    v_lshl_add_u32 v8, v8, 2, v9
    v_bfe_u32 v9, v3, 2, 1
    v_xor_b32 v9, v9, v4
    v_lshrrev_b32 v10, 4, v3
    v_or_b32 v9, v9, v10
    v_lshl_add_u32 v8, v9, 4, v8
    v_mov_b32 v5, 0xffff
    v_mov_b32 v6, 0xffff0000
    v_cmp_eq_u32 vcc, 0, v8
    s_nop 1
    v_cndmask_b32 v48, 0, v5, vcc
    v_cmp_eq_u32 vcc, 1, v8
    s_nop 1
    v_cndmask_b32 v48, v48, v6, vcc
    v_cmp_eq_u32 vcc, 2, v8
    s_nop 1
    v_cndmask_b32 v49, 0, v5, vcc
    v_cmp_eq_u32 vcc, 3, v8
    s_nop 1
    v_cndmask_b32 v49, v49, v6, vcc
    v_cmp_eq_u32 vcc, 4, v8
    s_nop 1
    v_cndmask_b32 v50, 0, v5, vcc
    v_cmp_eq_u32 vcc, 5, v8
    s_nop 1
    v_cndmask_b32 v50, v50, v6, vcc
    v_cmp_eq_u32 vcc, 6, v8
    s_nop 1
    v_cndmask_b32 v51, 0, v5, vcc
    v_cmp_eq_u32 vcc, 7, v8
    s_nop 1
    v_cndmask_b32 v51, v51, v6, vcc
    v_add_u32 v7, 0x10000, v2
    v_lshlrev_b32 v9, 5, v4
    v_add_u32 v9, 98304, v9
    s_and_b32 s44, s2, 7
    s_lshr_b32 s45, s2, 3
    s_and_b32 s40, s45, 7
    s_and_b32 s46, s44, 1
    s_lshl_b32 s46, s46, 3
    s_add_u32 s40, s40, s46
    s_lshr_b32 s44, s44, 1
    s_lshl_b32 s44, s44, 2
    s_lshr_b32 s45, s45, 3
    s_add_u32 s44, s44, s45
    s_lshl_b32 s41, s44, 2
    s_add_u32 s41, s41, s30
    s_lshl_b32 s42, s41, 15
    s_mul_i32 s96, s40, 98304
    s_mul_i32 s97, s30, 3072
    s_add_u32 s96, s96, s97
    s_add_u32 s96, s96, 2097152
    s_mov_b32 s48, s14
    s_and_b32 s49, s15, 0xffff
    s_mov_b32 s50, 1835008
    s_mov_b32 s51, 0x20000
    s_mov_b32 s52, s16
    s_and_b32 s53, s17, 0xffff
    s_mov_b32 s54, 1835008
    s_mov_b32 s55, 0x20000
    s_sub_u32 s56, s2, 224
    s_cmp_ge_u32 s2, 224
    s_cselect_b32 s56, s56, s2
    s_mul_i32 s57, s56, 2341
    s_lshr_b32 s57, s57, 16
    s_mul_i32 s58, s57, 28
    s_sub_u32 s58, s56, s58
    v_lshrrev_b32 v220, 3, v1
    v_and_b32 v221, 7, v1
    v_bfe_u32 v222, v220, 1, 1
    v_lshlrev_b32 v222, 2, v222
    v_xor_b32 v221, v221, v222
    v_mul_u32_u24 v220, 3584, v220
    v_lshl_add_u32 v220, v221, 4, v220
    s_lshl_b32 s59, s57, 2
    s_add_u32 s59, s59, s30
    s_mul_i32 s59, s59, 57344
    s_lshl_b32 s63, s58, 7
    s_add_u32 s59, s59, s63
    s_lshl_b32 s63, s30, 12
    s_add_u32 s63, s63, 100352
    s_lshl_b32 s46, s57, 7
    s_add_u32 s46, s46, 3689472
    s_lshl_b32 s47, s57, 8
    s_add_u32 s47, s47, 3678208
    s_lshl_b32 s56, s2, 2
    s_add_u32 s56, s56, s30
    s_lshl_b32 s38, s56, 9
    v_add_u32 v226, s38, v2
    v_min_u32 v226, 524272, v226
    s_lshr_b32 s38, s2, 3
    s_lshl_b32 s38, s38, 2
    s_add_u32 s38, s38, s30
    s_lshl_b32 s38, s38, 12
    v_bfe_u32 v227, v1, 3, 2
    v_lshlrev_b32 v227, 10, v227
    v_and_b32 v228, 7, v1
    v_lshl_add_u32 v227, v228, 4, v227
    v_add_u32 v227, s38, v227
    v_add_u32 v227, 384, v227
    s_and_b32 s60, s2, 7
    s_lshl_b32 s60, s60, 8
    s_lshr_b32 s61, s40, 2
    s_lshl_b32 s61, s61, 11
    s_add_u32 s61, s61, s60
    s_add_u32 s61, s61, 3936256
    v_mov_b32 v12, s61
    s_lshl_b32 s61, s44, 8
    s_add_u32 s61, s61, 3932160
    v_mov_b32 v13, s61
    v_cmp_eq_u32 vcc, 0, v1
    s_nop 1
    v_cndmask_b32 v12, v12, v13, vcc
    v_mov_b32 v13, 16
    v_mov_b32 v14, 8
    v_cndmask_b32 v13, v13, v14, vcc
    v_lshlrev_b32 v14, 11, v1
    v_add_u32 v14, 3946496, v14
    v_add_u32 v14, s60, v14
    s_nop 1
    s_cmp_lg_u32 s30, 0
    s_cbranch_scc1 s0w_w
    s_mov_b32 s61, 0
    s_mov_b64 exec, 3
s0w_poll:
    buffer_load_dword v10, v12, s[32:35], 0 offen sc1
    s_add_u32 s61, s61, 1
    s_waitcnt vmcnt(0)
    v_cmp_ne_u32 vcc, v10, v13
    s_nop 4
    s_cbranch_vccz s0w_done
    s_cmp_lt_u32 s61, 400000
    s_cbranch_scc1 s0w_poll
s0w_done:
    s_mov_b64 exec, -1
s0w_w:
    s_barrier
    s_cmp_ge_u32 s2, 48
    s_cbranch_scc1 s0b_done
    s_lshr_b32 s60, s2, 4
    s_lshl_b32 s60, s60, 11
    s_add_u32 s60, s60, 3944448
    s_cmp_lg_u32 s30, 0
    s_cbranch_scc1 s0b_skip
    v_lshlrev_b32 v10, 8, v1
    v_mov_b32 v11, 1
    s_mov_b64 exec, 0xff
    buffer_atomic_add v11, v10, s[32:35], s60 offen
    s_mov_b64 exec, -1
s0b_skip:
s0b_done:
    s_mov_b32 s36, 1069066811
    s_mov_b32 s37, 1069066811
    s_add_u32 m0, s97, 0
    s_add_u32 s98, s96, 0
    buffer_load_dwordx4 v2, s[32:35], s98 offen sc1 lds
    buffer_load_dwordx4 v2, s[32:35], s98 offen offset:1024 sc1 lds
    buffer_load_dwordx4 v2, s[32:35], s98 offen offset:2048 sc1 lds
    s_add_u32 s43, s42, 0
    buffer_load_dwordx4 a[0:3], v2, s[32:35], s43 offen offset:0 sc1
    buffer_load_dwordx4 a[4:7], v2, s[32:35], s43 offen offset:1024 sc1
    buffer_load_dwordx4 a[8:11], v2, s[32:35], s43 offen offset:2048 sc1
    buffer_load_dwordx4 a[12:15], v2, s[32:35], s43 offen offset:3072 sc1
    s_add_u32 m0, s97, 12288
    s_add_u32 s98, s96, 12288
    buffer_load_dwordx4 v2, s[32:35], s98 offen sc1 lds
    buffer_load_dwordx4 v2, s[32:35], s98 offen offset:1024 sc1 lds
    buffer_load_dwordx4 v2, s[32:35], s98 offen offset:2048 sc1 lds
    s_add_u32 s43, s42, 4096
    buffer_load_dwordx4 a[16:19], v2, s[32:35], s43 offen offset:0 sc1
    buffer_load_dwordx4 a[20:23], v2, s[32:35], s43 offen offset:1024 sc1
    buffer_load_dwordx4 a[24:27], v2, s[32:35], s43 offen offset:2048 sc1
    buffer_load_dwordx4 a[28:31], v2, s[32:35], s43 offen offset:3072 sc1
    s_lshl_b32 s38, s30, 10
    s_add_u32 s38, s38, 3670016
    s_mov_b32 s61, 0
tab_poll:
    buffer_load_dwordx4 v[56:59], v2, s[32:35], s38 offen sc1
    s_add_u32 s61, s61, 1
    s_waitcnt vmcnt(0)
    v_and_b32 v60, v56, v57
    v_and_b32 v61, v58, v59
    v_and_b32 v60, v60, v61
    v_and_b32 v60, 1, v60
    v_cmp_ne_u32 vcc, 1, v60
    s_nop 4
    s_cbranch_vccz tab_ok
    s_cmp_lt_u32 s61, 400000
    s_cbranch_scc1 tab_poll
tab_ok:
    v_and_b32 v56, 0xffff0000, v56
    v_and_b32 v57, 0xffff0000, v57
    v_and_b32 v58, 0xffff0000, v58
    v_and_b32 v59, 0xffff0000, v59
    s_cmp_ge_u32 s30, 2
    s_cbranch_scc1 tab_g
    s_lshl_b32 s38, s30, 10
    s_add_u32 s38, s38, 98304
    v_add_u32 v60, s38, v2
    ds_write_b128 v60, v[56:59]
    s_branch tab_done
tab_g:
    v_lshrrev_b32 v60, 2, v1
    s_sub_u32 s38, s30, 2
    s_lshl_b32 s38, s38, 4
    v_add_u32 v60, s38, v60
    v_lshrrev_b32 v61, 2, v60
    v_lshlrev_b32 v61, 10, v61
    v_and_b32 v60, 3, v60
    v_lshl_add_u32 v61, v60, 2, v61
    v_and_b32 v60, 1, v1
    v_lshl_add_u32 v61, v60, 7, v61
    v_bfe_u32 v60, v1, 1, 1
    v_mul_u32_u24 v60, 576, v60
    v_add_u32 v61, v61, v60
    v_add_u32 v61, 116736, v61
    v_lshrrev_b32 v60, 16, v56
    v_or_b32 v56, v56, v60
    ds_write_b32 v61, v56 offset:0
    v_lshrrev_b32 v60, 16, v57
    v_or_b32 v57, v57, v60
    ds_write_b32 v61, v57 offset:16
    v_lshrrev_b32 v60, 16, v58
    v_or_b32 v58, v58, v60
    ds_write_b32 v61, v58 offset:32
    v_lshrrev_b32 v60, 16, v59
    v_or_b32 v59, v59, v60
    ds_write_b32 v61, v59 offset:48
tab_done:
    s_nop 0
    s_waitcnt lgkmcnt(0)
    v_add_u32 v11, 116736, v2
    s_barrier
    ds_read_b128 v[16:19], v11 offset:0
    ds_read_b128 v[20:23], v11 offset:1024
    ds_read_b128 v[24:27], v11 offset:2048
    ds_read_b128 v[28:31], v11 offset:3072
    ds_read_b128 v[32:35], v11 offset:4096
    ds_read_b128 v[36:39], v11 offset:5120
    ds_read_b128 v[40:43], v11 offset:6144
    ds_read_b128 v[44:47], v11 offset:7168
    ds_read_b128 v[56:59], v9 offset:0
    ds_read_b128 v[60:63], v9 offset:16
    ds_read_b128 v[72:75], v9 offset:64
    ds_read_b128 v[76:79], v9 offset:80
    ds_read_b128 v[96:99], v2 offset:0
    ds_read_b128 v[100:103], v2 offset:1024
    ds_read_b128 v[104:107], v2 offset:2048
    s_waitcnt lgkmcnt(7)
    v_and_b32 v52, v16, v48
    v_and_b32 v53, v16, v49
    v_and_b32 v54, v16, v50
    v_and_b32 v55, v16, v51
    s_waitcnt lgkmcnt(5)
    s_nop 0
    v_mfma_f32_32x32x16_bf16 v[56:71], v[52:55], a[0:3], v[56:71]
    v_and_b32 v52, v17, v48
    v_and_b32 v53, v17, v49
    v_and_b32 v54, v17, v50
    v_and_b32 v55, v17, v51
    s_nop 7
    v_cvt_pk_bf16_f32 v88, v56, v57
    v_cvt_pk_bf16_f32 v89, v58, v59
    v_cvt_pk_bf16_f32 v90, v60, v61
    v_cvt_pk_bf16_f32 v91, v62, v63
    s_waitcnt lgkmcnt(0)
    v_mfma_f32_32x32x16_bf16 v[72:87], v[52:55], a[4:7], v[72:87]
    ds_read_b128 v[108:111], v2 offset:3072
    ds_read_b128 v[112:115], v2 offset:4096
    ds_read_b128 v[116:119], v2 offset:5120
    v_mfma_f32_32x32x16_bf16 v[120:135], v[96:99], v[88:91], 0
    ds_read_b128 v[56:59], v9 offset:128
    ds_read_b128 v[60:63], v9 offset:144
    s_add_u32 m0, s97, 24576
    s_add_u32 s98, s96, 24576
    buffer_load_dwordx4 v2, s[32:35], s98 offen sc1 lds
    v_mfma_f32_32x32x16_bf16 v[136:151], v[100:103], v[88:91], 0
    v_and_b32 v52, v18, v48
    v_and_b32 v53, v18, v49
    v_and_b32 v54, v18, v50
    v_and_b32 v55, v18, v51
    v_mfma_f32_32x32x16_bf16 v[152:167], v[88:91], v[104:107], 0
    buffer_load_dwordx4 v2, s[32:35], s98 offen offset:1024 sc1 lds
    v_cvt_pk_bf16_f32 v92, v72, v73
    v_cvt_pk_bf16_f32 v93, v74, v75
    v_cvt_pk_bf16_f32 v94, v76, v77
    v_cvt_pk_bf16_f32 v95, v78, v79
    s_waitcnt lgkmcnt(0)
    v_mfma_f32_32x32x16_bf16 v[56:71], v[52:55], a[8:11], v[56:71]
    ds_read_b128 v[96:99], v2 offset:6144
    ds_read_b128 v[100:103], v2 offset:7168
    ds_read_b128 v[104:107], v2 offset:8192
    v_mfma_f32_32x32x16_bf16 v[120:135], v[108:111], v[92:95], v[120:135]
    ds_read_b128 v[72:75], v9 offset:192
    ds_read_b128 v[76:79], v9 offset:208
    buffer_load_dwordx4 v2, s[32:35], s98 offen offset:2048 sc1 lds
    v_mfma_f32_32x32x16_bf16 v[136:151], v[112:115], v[92:95], v[136:151]
    v_and_b32 v52, v19, v48
    v_and_b32 v53, v19, v49
    v_and_b32 v54, v19, v50
    v_and_b32 v55, v19, v51
    v_mfma_f32_32x32x16_bf16 v[152:167], v[92:95], v[116:119], v[152:167]
    s_add_u32 s43, s42, 8192
    buffer_load_dwordx4 a[32:35], v2, s[32:35], s43 offen offset:0 sc1
    v_cvt_pk_bf16_f32 v88, v56, v57
    v_cvt_pk_bf16_f32 v89, v58, v59
    v_cvt_pk_bf16_f32 v90, v60, v61
    v_cvt_pk_bf16_f32 v91, v62, v63
    s_waitcnt lgkmcnt(0)
    v_mfma_f32_32x32x16_bf16 v[72:87], v[52:55], a[12:15], v[72:87]
    ds_read_b128 v[108:111], v2 offset:9216
    ds_read_b128 v[112:115], v2 offset:10240
    ds_read_b128 v[116:119], v2 offset:11264
    v_mfma_f32_32x32x16_bf16 v[120:135], v[96:99], v[88:91], v[120:135]
    ds_read_b128 v[56:59], v9 offset:256
    ds_read_b128 v[60:63], v9 offset:272
    buffer_load_dwordx4 a[36:39], v2, s[32:35], s43 offen offset:1024 sc1
    v_mfma_f32_32x32x16_bf16 v[136:151], v[100:103], v[88:91], v[136:151]
    v_mfma_f32_32x32x16_bf16 v[152:167], v[88:91], v[104:107], v[152:167]
    buffer_load_dwordx4 a[40:43], v2, s[32:35], s43 offen offset:2048 sc1
    s_nop 1
    v_cvt_pk_bf16_f32 v92, v72, v73
    v_cvt_pk_bf16_f32 v93, v74, v75
    v_cvt_pk_bf16_f32 v94, v76, v77
    v_cvt_pk_bf16_f32 v95, v78, v79
    s_barrier
    v_and_b32 v52, v20, v48
    v_and_b32 v53, v20, v49
    v_and_b32 v54, v20, v50
    v_and_b32 v55, v20, v51
    s_waitcnt lgkmcnt(0)
    s_nop 0
    v_mfma_f32_32x32x16_bf16 v[56:71], v[52:55], a[16:19], v[56:71]
    ds_read_b128 v[96:99], v2 offset:12288
    ds_read_b128 v[100:103], v2 offset:13312
    ds_read_b128 v[104:107], v2 offset:14336
    v_mfma_f32_32x32x16_bf16 v[120:135], v[108:111], v[92:95], v[120:135]
    ds_read_b128 v[72:75], v9 offset:320
    ds_read_b128 v[76:79], v9 offset:336
    buffer_load_dwordx4 a[44:47], v2, s[32:35], s43 offen offset:3072 sc1
    v_mfma_f32_32x32x16_bf16 v[136:151], v[112:115], v[92:95], v[136:151]
    v_and_b32 v52, v21, v48
    v_and_b32 v53, v21, v49
    v_and_b32 v54, v21, v50
    v_and_b32 v55, v21, v51
    v_mfma_f32_32x32x16_bf16 v[152:167], v[92:95], v[116:119], v[152:167]
    s_add_u32 m0, s97, 36864
    s_add_u32 s98, s96, 36864
    buffer_load_dwordx4 v2, s[32:35], s98 offen sc1 lds
    v_cvt_pk_bf16_f32 v88, v56, v57
    v_cvt_pk_bf16_f32 v89, v58, v59
    v_cvt_pk_bf16_f32 v90, v60, v61
    v_cvt_pk_bf16_f32 v91, v62, v63
    s_waitcnt lgkmcnt(0)
    v_mfma_f32_32x32x16_bf16 v[72:87], v[52:55], a[20:23], v[72:87]
    ds_read_b128 v[108:111], v2 offset:15360
    ds_read_b128 v[112:115], v2 offset:16384
    ds_read_b128 v[116:119], v2 offset:17408
    v_mfma_f32_32x32x16_bf16 v[120:135], v[96:99], v[88:91], v[120:135]
    ds_read_b128 v[56:59], v9 offset:384
    ds_read_b128 v[60:63], v9 offset:400
    buffer_load_dwordx4 v2, s[32:35], s98 offen offset:1024 sc1 lds
    v_mfma_f32_32x32x16_bf16 v[136:151], v[100:103], v[88:91], v[136:151]
    v_and_b32 v52, v22, v48
    v_and_b32 v53, v22, v49
    v_and_b32 v54, v22, v50
    v_and_b32 v55, v22, v51
    v_mfma_f32_32x32x16_bf16 v[152:167], v[88:91], v[104:107], v[152:167]
    buffer_load_dwordx4 v2, s[32:35], s98 offen offset:2048 sc1 lds
    v_cvt_pk_bf16_f32 v92, v72, v73
    v_cvt_pk_bf16_f32 v93, v74, v75
    v_cvt_pk_bf16_f32 v94, v76, v77
    v_cvt_pk_bf16_f32 v95, v78, v79
    s_waitcnt lgkmcnt(0)
    v_mfma_f32_32x32x16_bf16 v[56:71], v[52:55], a[24:27], v[56:71]
    ds_read_b128 v[96:99], v2 offset:18432
    ds_read_b128 v[100:103], v2 offset:19456
    ds_read_b128 v[104:107], v2 offset:20480
    v_mfma_f32_32x32x16_bf16 v[120:135], v[108:111], v[92:95], v[120:135]
    ds_read_b128 v[72:75], v9 offset:448
    ds_read_b128 v[76:79], v9 offset:464
    s_add_u32 s43, s42, 12288
    buffer_load_dwordx4 a[48:51], v2, s[32:35], s43 offen offset:0 sc1
    v_mfma_f32_32x32x16_bf16 v[136:151], v[112:115], v[92:95], v[136:151]
    v_and_b32 v52, v23, v48
    v_and_b32 v53, v23, v49
    v_and_b32 v54, v23, v50
    v_and_b32 v55, v23, v51
    v_mfma_f32_32x32x16_bf16 v[152:167], v[92:95], v[116:119], v[152:167]
    buffer_load_dwordx4 a[52:55], v2, s[32:35], s43 offen offset:1024 sc1
    v_cvt_pk_bf16_f32 v88, v56, v57
    v_cvt_pk_bf16_f32 v89, v58, v59
    v_cvt_pk_bf16_f32 v90, v60, v61
    v_cvt_pk_bf16_f32 v91, v62, v63
    s_mov_b64 exec, 7
    buffer_load_dword v15, v14, s[32:35], 0 offen sc1
    s_mov_b64 exec, -1
    s_waitcnt lgkmcnt(0)
    v_mfma_f32_32x32x16_bf16 v[72:87], v[52:55], a[28:31], v[72:87]
    ds_read_b128 v[108:111], v2 offset:21504
    ds_read_b128 v[112:115], v2 offset:22528
    ds_read_b128 v[116:119], v2 offset:23552
    v_mfma_f32_32x32x16_bf16 v[120:135], v[96:99], v[88:91], v[120:135]
    ds_read_b128 v[56:59], v9 offset:512
    ds_read_b128 v[60:63], v9 offset:528
    buffer_load_dwordx4 a[56:59], v2, s[32:35], s43 offen offset:2048 sc1
    v_mfma_f32_32x32x16_bf16 v[136:151], v[100:103], v[88:91], v[136:151]
    v_mfma_f32_32x32x16_bf16 v[152:167], v[88:91], v[104:107], v[152:167]
    buffer_load_dwordx4 a[60:63], v2, s[32:35], s43 offen offset:3072 sc1
    s_nop 1
    v_cvt_pk_bf16_f32 v92, v72, v73
    v_cvt_pk_bf16_f32 v93, v74, v75
    v_cvt_pk_bf16_f32 v94, v76, v77
    v_cvt_pk_bf16_f32 v95, v78, v79
    s_waitcnt vmcnt(8)
    s_barrier
    v_and_b32 v52, v24, v48
    v_and_b32 v53, v24, v49
    v_and_b32 v54, v24, v50
    v_and_b32 v55, v24, v51
    s_waitcnt lgkmcnt(0)
    s_nop 0
    v_mfma_f32_32x32x16_bf16 v[56:71], v[52:55], a[32:35], v[56:71]
    ds_read_b128 v[96:99], v2 offset:24576
    ds_read_b128 v[100:103], v2 offset:25600
    ds_read_b128 v[104:107], v2 offset:26624
    v_mfma_f32_32x32x16_bf16 v[120:135], v[108:111], v[92:95], v[120:135]
    ds_read_b128 v[72:75], v9 offset:576
    ds_read_b128 v[76:79], v9 offset:592
    s_add_u32 m0, s97, 49152
    s_add_u32 s98, s96, 49152
    buffer_load_dwordx4 v2, s[32:35], s98 offen sc1 lds
    v_mfma_f32_32x32x16_bf16 v[136:151], v[112:115], v[92:95], v[136:151]
    v_and_b32 v52, v25, v48
    v_and_b32 v53, v25, v49
    v_and_b32 v54, v25, v50
    v_and_b32 v55, v25, v51
    v_mfma_f32_32x32x16_bf16 v[152:167], v[92:95], v[116:119], v[152:167]
    buffer_load_dwordx4 v2, s[32:35], s98 offen offset:1024 sc1 lds
    v_cvt_pk_bf16_f32 v88, v56, v57
    v_cvt_pk_bf16_f32 v89, v58, v59
    v_cvt_pk_bf16_f32 v90, v60, v61
    v_cvt_pk_bf16_f32 v91, v62, v63
    s_waitcnt lgkmcnt(0)
    v_mfma_f32_32x32x16_bf16 v[72:87], v[52:55], a[36:39], v[72:87]
    ds_read_b128 v[108:111], v2 offset:27648
    ds_read_b128 v[112:115], v2 offset:28672
    ds_read_b128 v[116:119], v2 offset:29696
    v_mfma_f32_32x32x16_bf16 v[120:135], v[96:99], v[88:91], v[120:135]
    ds_read_b128 v[56:59], v9 offset:640
    ds_read_b128 v[60:63], v9 offset:656
    buffer_load_dwordx4 v2, s[32:35], s98 offen offset:2048 sc1 lds
    v_mfma_f32_32x32x16_bf16 v[136:151], v[100:103], v[88:91], v[136:151]
    v_and_b32 v52, v26, v48
    v_and_b32 v53, v26, v49
    v_and_b32 v54, v26, v50
    v_and_b32 v55, v26, v51
    v_mfma_f32_32x32x16_bf16 v[152:167], v[88:91], v[104:107], v[152:167]
    s_add_u32 s43, s42, 16384
    buffer_load_dwordx4 a[64:67], v2, s[32:35], s43 offen offset:0 sc1
    v_cvt_pk_bf16_f32 v92, v72, v73
    v_cvt_pk_bf16_f32 v93, v74, v75
    v_cvt_pk_bf16_f32 v94, v76, v77
    v_cvt_pk_bf16_f32 v95, v78, v79
    s_waitcnt lgkmcnt(0)
    v_mfma_f32_32x32x16_bf16 v[56:71], v[52:55], a[40:43], v[56:71]
    ds_read_b128 v[96:99], v2 offset:30720
    ds_read_b128 v[100:103], v2 offset:31744
    ds_read_b128 v[104:107], v2 offset:32768
    v_mfma_f32_32x32x16_bf16 v[120:135], v[108:111], v[92:95], v[120:135]
    ds_read_b128 v[72:75], v9 offset:704
    ds_read_b128 v[76:79], v9 offset:720
    buffer_load_dwordx4 a[68:71], v2, s[32:35], s43 offen offset:1024 sc1
    v_mfma_f32_32x32x16_bf16 v[136:151], v[112:115], v[92:95], v[136:151]
    v_and_b32 v52, v27, v48
    v_and_b32 v53, v27, v49
    v_and_b32 v54, v27, v50
    v_and_b32 v55, v27, v51
    v_mfma_f32_32x32x16_bf16 v[152:167], v[92:95], v[116:119], v[152:167]
    buffer_load_dwordx4 a[72:75], v2, s[32:35], s43 offen offset:2048 sc1
    v_cvt_pk_bf16_f32 v88, v56, v57
    v_cvt_pk_bf16_f32 v89, v58, v59
    v_cvt_pk_bf16_f32 v90, v60, v61
    v_cvt_pk_bf16_f32 v91, v62, v63
    s_waitcnt lgkmcnt(0)
    v_mfma_f32_32x32x16_bf16 v[72:87], v[52:55], a[44:47], v[72:87]
    ds_read_b128 v[108:111], v2 offset:33792
    ds_read_b128 v[112:115], v2 offset:34816
    ds_read_b128 v[116:119], v2 offset:35840
    v_mfma_f32_32x32x16_bf16 v[120:135], v[96:99], v[88:91], v[120:135]
    ds_read_b128 v[56:59], v9 offset:768
    ds_read_b128 v[60:63], v9 offset:784
    buffer_load_dwordx4 a[76:79], v2, s[32:35], s43 offen offset:3072 sc1
    v_mfma_f32_32x32x16_bf16 v[136:151], v[100:103], v[88:91], v[136:151]
    v_mfma_f32_32x32x16_bf16 v[152:167], v[88:91], v[104:107], v[152:167]
    s_add_u32 m0, s97, 61440
    s_add_u32 s98, s96, 61440
    buffer_load_dwordx4 v2, s[32:35], s98 offen sc1 lds
    v_cvt_pk_bf16_f32 v92, v72, v73
    v_cvt_pk_bf16_f32 v93, v74, v75
    v_cvt_pk_bf16_f32 v94, v76, v77
    v_cvt_pk_bf16_f32 v95, v78, v79
    s_waitcnt vmcnt(8)
    s_barrier
    v_and_b32 v52, v28, v48
    v_and_b32 v53, v28, v49
    v_and_b32 v54, v28, v50
    v_and_b32 v55, v28, v51
    s_waitcnt lgkmcnt(0)
    s_nop 0
    v_mfma_f32_32x32x16_bf16 v[56:71], v[52:55], a[48:51], v[56:71]
    ds_read_b128 v[96:99], v2 offset:36864
    ds_read_b128 v[100:103], v2 offset:37888
    ds_read_b128 v[104:107], v2 offset:38912
    v_mfma_f32_32x32x16_bf16 v[120:135], v[108:111], v[92:95], v[120:135]
    ds_read_b128 v[72:75], v9 offset:832
    ds_read_b128 v[76:79], v9 offset:848
    buffer_load_dwordx4 v2, s[32:35], s98 offen offset:1024 sc1 lds
    v_mfma_f32_32x32x16_bf16 v[136:151], v[112:115], v[92:95], v[136:151]
    v_and_b32 v52, v29, v48
    v_and_b32 v53, v29, v49
    v_and_b32 v54, v29, v50
    v_and_b32 v55, v29, v51
    v_mfma_f32_32x32x16_bf16 v[152:167], v[92:95], v[116:119], v[152:167]
    buffer_load_dwordx4 v2, s[32:35], s98 offen offset:2048 sc1 lds
    v_cvt_pk_bf16_f32 v88, v56, v57
    v_cvt_pk_bf16_f32 v89, v58, v59
    v_cvt_pk_bf16_f32 v90, v60, v61
    v_cvt_pk_bf16_f32 v91, v62, v63
    s_waitcnt lgkmcnt(0)
    v_mfma_f32_32x32x16_bf16 v[72:87], v[52:55], a[52:55], v[72:87]
    ds_read_b128 v[108:111], v2 offset:39936
    ds_read_b128 v[112:115], v2 offset:40960
    ds_read_b128 v[116:119], v2 offset:41984
    v_mfma_f32_32x32x16_bf16 v[120:135], v[96:99], v[88:91], v[120:135]
    ds_read_b128 v[56:59], v9 offset:896
    ds_read_b128 v[60:63], v9 offset:912
    s_add_u32 s43, s42, 20480
    buffer_load_dwordx4 a[80:83], v2, s[32:35], s43 offen offset:0 sc1
    v_mfma_f32_32x32x16_bf16 v[136:151], v[100:103], v[88:91], v[136:151]
    v_and_b32 v52, v30, v48
    v_and_b32 v53, v30, v49
    v_and_b32 v54, v30, v50
    v_and_b32 v55, v30, v51
    v_mfma_f32_32x32x16_bf16 v[152:167], v[88:91], v[104:107], v[152:167]
    buffer_load_dwordx4 a[84:87], v2, s[32:35], s43 offen offset:1024 sc1
    v_cvt_pk_bf16_f32 v92, v72, v73
    v_cvt_pk_bf16_f32 v93, v74, v75
    v_cvt_pk_bf16_f32 v94, v76, v77
    v_cvt_pk_bf16_f32 v95, v78, v79
    s_waitcnt lgkmcnt(0)
    v_mfma_f32_32x32x16_bf16 v[56:71], v[52:55], a[56:59], v[56:71]
    ds_read_b128 v[96:99], v2 offset:43008
    ds_read_b128 v[100:103], v2 offset:44032
    ds_read_b128 v[104:107], v2 offset:45056
    v_mfma_f32_32x32x16_bf16 v[120:135], v[108:111], v[92:95], v[120:135]
    ds_read_b128 v[72:75], v9 offset:960
    ds_read_b128 v[76:79], v9 offset:976
    buffer_load_dwordx4 a[88:91], v2, s[32:35], s43 offen offset:2048 sc1
    v_mfma_f32_32x32x16_bf16 v[136:151], v[112:115], v[92:95], v[136:151]
    v_and_b32 v52, v31, v48
    v_and_b32 v53, v31, v49
    v_and_b32 v54, v31, v50
    v_and_b32 v55, v31, v51
    v_mfma_f32_32x32x16_bf16 v[152:167], v[92:95], v[116:119], v[152:167]
    buffer_load_dwordx4 a[92:95], v2, s[32:35], s43 offen offset:3072 sc1
    v_cvt_pk_bf16_f32 v88, v56, v57
    v_cvt_pk_bf16_f32 v89, v58, v59
    v_cvt_pk_bf16_f32 v90, v60, v61
    v_cvt_pk_bf16_f32 v91, v62, v63
    s_nop 6
    s_mov_b32 s61, 0
    s_mov_b64 exec, 7
modc_chk:
    v_cmp_ne_u32 vcc, 16, v15
    s_nop 4
    s_cbranch_vccz modc_ok
    buffer_load_dword v15, v14, s[32:35], 0 offen sc1
    s_add_u32 s61, s61, 1
    s_waitcnt vmcnt(0)
    s_cmp_lt_u32 s61, 400000
    s_cbranch_scc1 modc_chk
modc_ok:
    s_mov_b64 exec, -1
    s_waitcnt lgkmcnt(0)
    v_mfma_f32_32x32x16_bf16 v[72:87], v[52:55], a[60:63], v[72:87]
    ds_read_b128 v[108:111], v2 offset:46080
    ds_read_b128 v[112:115], v2 offset:47104
    ds_read_b128 v[116:119], v2 offset:48128
    v_mfma_f32_32x32x16_bf16 v[120:135], v[96:99], v[88:91], v[120:135]
    ds_read_b128 v[56:59], v9 offset:1024
    ds_read_b128 v[60:63], v9 offset:1040
    s_add_u32 m0, s97, 73728
    s_add_u32 s98, s96, 73728
    buffer_load_dwordx4 v2, s[32:35], s98 offen sc1 lds
    v_mfma_f32_32x32x16_bf16 v[136:151], v[100:103], v[88:91], v[136:151]
    v_mfma_f32_32x32x16_bf16 v[152:167], v[88:91], v[104:107], v[152:167]
    buffer_load_dwordx4 v2, s[32:35], s98 offen offset:1024 sc1 lds
    v_cvt_pk_bf16_f32 v92, v72, v73
    v_cvt_pk_bf16_f32 v93, v74, v75
    v_cvt_pk_bf16_f32 v94, v76, v77
    v_cvt_pk_bf16_f32 v95, v78, v79
    s_waitcnt vmcnt(9)
    s_barrier
    v_and_b32 v52, v32, v48
    v_and_b32 v53, v32, v49
    v_and_b32 v54, v32, v50
    v_and_b32 v55, v32, v51
    s_waitcnt lgkmcnt(0)
    s_nop 0
    v_mfma_f32_32x32x16_bf16 v[56:71], v[52:55], a[64:67], v[56:71]
    ds_read_b128 v[96:99], v2 offset:49152
    ds_read_b128 v[100:103], v2 offset:50176
    ds_read_b128 v[104:107], v2 offset:51200
    v_mfma_f32_32x32x16_bf16 v[120:135], v[108:111], v[92:95], v[120:135]
    ds_read_b128 v[72:75], v9 offset:1088
    ds_read_b128 v[76:79], v9 offset:1104
    buffer_load_dwordx4 v2, s[32:35], s98 offen offset:2048 sc1 lds
    v_mfma_f32_32x32x16_bf16 v[136:151], v[112:115], v[92:95], v[136:151]
    v_and_b32 v52, v33, v48
    v_and_b32 v53, v33, v49
    v_and_b32 v54, v33, v50
    v_and_b32 v55, v33, v51
    v_mfma_f32_32x32x16_bf16 v[152:167], v[92:95], v[116:119], v[152:167]
    s_add_u32 s43, s42, 24576
    buffer_load_dwordx4 a[96:99], v2, s[32:35], s43 offen offset:0 sc1
    v_cvt_pk_bf16_f32 v88, v56, v57
    v_cvt_pk_bf16_f32 v89, v58, v59
    v_cvt_pk_bf16_f32 v90, v60, v61
    v_cvt_pk_bf16_f32 v91, v62, v63
    s_waitcnt lgkmcnt(0)
    v_mfma_f32_32x32x16_bf16 v[72:87], v[52:55], a[68:71], v[72:87]
    ds_read_b128 v[108:111], v2 offset:52224
    ds_read_b128 v[112:115], v2 offset:53248
    ds_read_b128 v[116:119], v2 offset:54272
    v_mfma_f32_32x32x16_bf16 v[120:135], v[96:99], v[88:91], v[120:135]
    ds_read_b128 v[56:59], v9 offset:1152
    ds_read_b128 v[60:63], v9 offset:1168
    buffer_load_dwordx4 a[100:103], v2, s[32:35], s43 offen offset:1024 sc1
    v_mfma_f32_32x32x16_bf16 v[136:151], v[100:103], v[88:91], v[136:151]
    v_and_b32 v52, v34, v48
    v_and_b32 v53, v34, v49
    v_and_b32 v54, v34, v50
    v_and_b32 v55, v34, v51
    v_mfma_f32_32x32x16_bf16 v[152:167], v[88:91], v[104:107], v[152:167]
    buffer_load_dwordx4 a[104:107], v2, s[32:35], s43 offen offset:2048 sc1
    v_cvt_pk_bf16_f32 v92, v72, v73
    v_cvt_pk_bf16_f32 v93, v74, v75
    v_cvt_pk_bf16_f32 v94, v76, v77
    v_cvt_pk_bf16_f32 v95, v78, v79
    s_waitcnt lgkmcnt(0)
    v_mfma_f32_32x32x16_bf16 v[56:71], v[52:55], a[72:75], v[56:71]
    ds_read_b128 v[96:99], v2 offset:55296
    ds_read_b128 v[100:103], v2 offset:56320
    ds_read_b128 v[104:107], v2 offset:57344
    v_mfma_f32_32x32x16_bf16 v[120:135], v[108:111], v[92:95], v[120:135]
    ds_read_b128 v[72:75], v9 offset:1216
    ds_read_b128 v[76:79], v9 offset:1232
    buffer_load_dwordx4 a[108:111], v2, s[32:35], s43 offen offset:3072 sc1
    v_mfma_f32_32x32x16_bf16 v[136:151], v[112:115], v[92:95], v[136:151]
    v_and_b32 v52, v35, v48
    v_and_b32 v53, v35, v49
    v_and_b32 v54, v35, v50
    v_and_b32 v55, v35, v51
    v_mfma_f32_32x32x16_bf16 v[152:167], v[92:95], v[116:119], v[152:167]
    s_add_u32 m0, s97, 86016
    s_add_u32 s98, s96, 86016
    buffer_load_dwordx4 v2, s[32:35], s98 offen sc1 lds
    v_cvt_pk_bf16_f32 v88, v56, v57
    v_cvt_pk_bf16_f32 v89, v58, v59
    v_cvt_pk_bf16_f32 v90, v60, v61
    v_cvt_pk_bf16_f32 v91, v62, v63
    s_waitcnt lgkmcnt(0)
    v_mfma_f32_32x32x16_bf16 v[72:87], v[52:55], a[76:79], v[72:87]
    ds_read_b128 v[108:111], v2 offset:58368
    ds_read_b128 v[112:115], v2 offset:59392
    ds_read_b128 v[116:119], v2 offset:60416
    v_mfma_f32_32x32x16_bf16 v[120:135], v[96:99], v[88:91], v[120:135]
    ds_read_b128 v[56:59], v9 offset:1280
    ds_read_b128 v[60:63], v9 offset:1296
    buffer_load_dwordx4 v2, s[32:35], s98 offen offset:1024 sc1 lds
    v_mfma_f32_32x32x16_bf16 v[136:151], v[100:103], v[88:91], v[136:151]
    v_mfma_f32_32x32x16_bf16 v[152:167], v[88:91], v[104:107], v[152:167]
    buffer_load_dwordx4 v2, s[32:35], s98 offen offset:2048 sc1 lds
    s_nop 1
    v_cvt_pk_bf16_f32 v92, v72, v73
    v_cvt_pk_bf16_f32 v93, v74, v75
    v_cvt_pk_bf16_f32 v94, v76, v77
    v_cvt_pk_bf16_f32 v95, v78, v79
    s_waitcnt vmcnt(10)
    s_barrier
    v_and_b32 v52, v36, v48
    v_and_b32 v53, v36, v49
    v_and_b32 v54, v36, v50
    v_and_b32 v55, v36, v51
    s_waitcnt lgkmcnt(0)
    s_nop 0
    v_mfma_f32_32x32x16_bf16 v[56:71], v[52:55], a[80:83], v[56:71]
    ds_read_b128 v[96:99], v2 offset:61440
    ds_read_b128 v[100:103], v2 offset:62464
    ds_read_b128 v[104:107], v2 offset:63488
    v_mfma_f32_32x32x16_bf16 v[120:135], v[108:111], v[92:95], v[120:135]
    ds_read_b128 v[72:75], v9 offset:1344
    ds_read_b128 v[76:79], v9 offset:1360
    s_add_u32 s43, s42, 28672
    buffer_load_dwordx4 a[112:115], v2, s[32:35], s43 offen offset:0 sc1
    v_mfma_f32_32x32x16_bf16 v[136:151], v[112:115], v[92:95], v[136:151]
    v_and_b32 v52, v37, v48
    v_and_b32 v53, v37, v49
    v_and_b32 v54, v37, v50
    v_and_b32 v55, v37, v51
    v_mfma_f32_32x32x16_bf16 v[152:167], v[92:95], v[116:119], v[152:167]
    buffer_load_dwordx4 a[116:119], v2, s[32:35], s43 offen offset:1024 sc1
    v_cvt_pk_bf16_f32 v88, v56, v57
    v_cvt_pk_bf16_f32 v89, v58, v59
    v_cvt_pk_bf16_f32 v90, v60, v61
    v_cvt_pk_bf16_f32 v91, v62, v63
    s_waitcnt lgkmcnt(0)
    v_mfma_f32_32x32x16_bf16 v[72:87], v[52:55], a[84:87], v[72:87]
    ds_read_b128 v[108:111], v2 offset:64512
    ds_read_b128 v[112:115], v7 offset:0
    ds_read_b128 v[116:119], v7 offset:1024
    v_mfma_f32_32x32x16_bf16 v[120:135], v[96:99], v[88:91], v[120:135]
    ds_read_b128 v[56:59], v9 offset:1408
    ds_read_b128 v[60:63], v9 offset:1424
    buffer_load_dwordx4 a[120:123], v2, s[32:35], s43 offen offset:2048 sc1
    v_mfma_f32_32x32x16_bf16 v[136:151], v[100:103], v[88:91], v[136:151]
    v_and_b32 v52, v38, v48
    v_and_b32 v53, v38, v49
    v_and_b32 v54, v38, v50
    v_and_b32 v55, v38, v51
    v_mfma_f32_32x32x16_bf16 v[152:167], v[88:91], v[104:107], v[152:167]
    buffer_load_dwordx4 a[124:127], v2, s[32:35], s43 offen offset:3072 sc1
    v_cvt_pk_bf16_f32 v92, v72, v73
    v_cvt_pk_bf16_f32 v93, v74, v75
    v_cvt_pk_bf16_f32 v94, v76, v77
    v_cvt_pk_bf16_f32 v95, v78, v79
    s_waitcnt lgkmcnt(0)
    v_mfma_f32_32x32x16_bf16 v[56:71], v[52:55], a[88:91], v[56:71]
    ds_read_b128 v[96:99], v7 offset:2048
    ds_read_b128 v[100:103], v7 offset:3072
    ds_read_b128 v[104:107], v7 offset:4096
    v_mfma_f32_32x32x16_bf16 v[120:135], v[108:111], v[92:95], v[120:135]
    ds_read_b128 v[72:75], v9 offset:1472
    ds_read_b128 v[76:79], v9 offset:1488
    s_lshl_b32 s38, s40, 11
    s_add_u32 s38, s38, 3735552
    buffer_load_dwordx4 v[168:171], v2, s[32:35], s38 offen sc1
    v_mfma_f32_32x32x16_bf16 v[136:151], v[112:115], v[92:95], v[136:151]
    v_and_b32 v52, v39, v48
    v_and_b32 v53, v39, v49
    v_and_b32 v54, v39, v50
    v_and_b32 v55, v39, v51
    v_mfma_f32_32x32x16_bf16 v[152:167], v[92:95], v[116:119], v[152:167]
    buffer_load_dwordx4 v[172:175], v2, s[32:35], s38 offen offset:1024 sc1
    v_cvt_pk_bf16_f32 v88, v56, v57
    v_cvt_pk_bf16_f32 v89, v58, v59
    v_cvt_pk_bf16_f32 v90, v60, v61
    v_cvt_pk_bf16_f32 v91, v62, v63
    s_waitcnt lgkmcnt(0)
    v_mfma_f32_32x32x16_bf16 v[72:87], v[52:55], a[92:95], v[72:87]
    ds_read_b128 v[108:111], v7 offset:5120
    ds_read_b128 v[112:115], v7 offset:6144
    ds_read_b128 v[116:119], v7 offset:7168
    v_mfma_f32_32x32x16_bf16 v[120:135], v[96:99], v[88:91], v[120:135]
    ds_read_b128 v[56:59], v9 offset:1536
    ds_read_b128 v[60:63], v9 offset:1552
    s_add_u32 m0, s63, 0
    s_add_u32 s45, s59, 0
    buffer_load_dwordx4 v220, s[48:51], s45 offen nt lds
    v_mfma_f32_32x32x16_bf16 v[136:151], v[100:103], v[88:91], v[136:151]
    v_mfma_f32_32x32x16_bf16 v[152:167], v[88:91], v[104:107], v[152:167]
    s_add_u32 m0, s63, 1024
    s_add_u32 s45, s59, 28672
    buffer_load_dwordx4 v220, s[48:51], s45 offen nt lds
    v_cvt_pk_bf16_f32 v92, v72, v73
    v_cvt_pk_bf16_f32 v93, v74, v75
    v_cvt_pk_bf16_f32 v94, v76, v77
    v_cvt_pk_bf16_f32 v95, v78, v79
    s_waitcnt vmcnt(11)
    s_barrier
    v_and_b32 v52, v40, v48
    v_and_b32 v53, v40, v49
    v_and_b32 v54, v40, v50
    v_and_b32 v55, v40, v51
    s_waitcnt lgkmcnt(0)
    s_nop 0
    v_mfma_f32_32x32x16_bf16 v[56:71], v[52:55], a[96:99], v[56:71]
    ds_read_b128 v[96:99], v7 offset:8192
    ds_read_b128 v[100:103], v7 offset:9216
    ds_read_b128 v[104:107], v7 offset:10240
    v_mfma_f32_32x32x16_bf16 v[120:135], v[108:111], v[92:95], v[120:135]
    ds_read_b128 v[72:75], v9 offset:1600
    ds_read_b128 v[76:79], v9 offset:1616
    s_add_u32 m0, s63, 2048
    s_add_u32 s45, s59, 0
    buffer_load_dwordx4 v220, s[52:55], s45 offen nt lds
    v_mfma_f32_32x32x16_bf16 v[136:151], v[112:115], v[92:95], v[136:151]
    v_and_b32 v52, v41, v48
    v_and_b32 v53, v41, v49
    v_and_b32 v54, v41, v50
    v_and_b32 v55, v41, v51
    v_mfma_f32_32x32x16_bf16 v[152:167], v[92:95], v[116:119], v[152:167]
    s_add_u32 m0, s63, 3072
    s_add_u32 s45, s59, 28672
    buffer_load_dwordx4 v220, s[52:55], s45 offen nt lds
    v_cvt_pk_bf16_f32 v88, v56, v57
    v_cvt_pk_bf16_f32 v89, v58, v59
    v_cvt_pk_bf16_f32 v90, v60, v61
    v_cvt_pk_bf16_f32 v91, v62, v63
    s_waitcnt lgkmcnt(0)
    v_mfma_f32_32x32x16_bf16 v[72:87], v[52:55], a[100:103], v[72:87]
    ds_read_b128 v[108:111], v7 offset:11264
    ds_read_b128 v[112:115], v7 offset:12288
    ds_read_b128 v[116:119], v7 offset:13312
    v_mfma_f32_32x32x16_bf16 v[120:135], v[96:99], v[88:91], v[120:135]
    ds_read_b128 v[56:59], v9 offset:1664
    ds_read_b128 v[60:63], v9 offset:1680
    s_mov_b32 m0, 124928
    s_mov_b64 exec, 0xffff
    buffer_load_dwordx4 v2, s[32:35], s47 offen sc1 lds
    s_mov_b64 exec, -1
    v_mfma_f32_32x32x16_bf16 v[136:151], v[100:103], v[88:91], v[136:151]
    v_and_b32 v52, v42, v48
    v_and_b32 v53, v42, v49
    v_and_b32 v54, v42, v50
    v_and_b32 v55, v42, v51
    v_mfma_f32_32x32x16_bf16 v[152:167], v[88:91], v[104:107], v[152:167]
    s_mov_b32 m0, 125184
    s_mov_b64 exec, 0xff
    buffer_load_dwordx4 v2, s[32:35], s46 offen sc1 lds
    s_mov_b64 exec, -1
    v_cvt_pk_bf16_f32 v92, v72, v73
    v_cvt_pk_bf16_f32 v93, v74, v75
    v_cvt_pk_bf16_f32 v94, v76, v77
    v_cvt_pk_bf16_f32 v95, v78, v79
    s_waitcnt lgkmcnt(0)
    v_mfma_f32_32x32x16_bf16 v[56:71], v[52:55], a[104:107], v[56:71]
    ds_read_b128 v[96:99], v7 offset:14336
    ds_read_b128 v[100:103], v7 offset:15360
    ds_read_b128 v[104:107], v7 offset:16384
    v_mfma_f32_32x32x16_bf16 v[120:135], v[108:111], v[92:95], v[120:135]
    ds_read_b128 v[72:75], v9 offset:1728
    ds_read_b128 v[76:79], v9 offset:1744
    global_load_dwordx4 a[144:147], v226, s[10:11]
    v_mfma_f32_32x32x16_bf16 v[136:151], v[112:115], v[92:95], v[136:151]
    v_and_b32 v52, v43, v48
    v_and_b32 v53, v43, v49
    v_and_b32 v54, v43, v50
    v_and_b32 v55, v43, v51
    v_mfma_f32_32x32x16_bf16 v[152:167], v[92:95], v[116:119], v[152:167]
    global_load_dwordx4 a[144:147], v227, s[10:11]
    v_cvt_pk_bf16_f32 v88, v56, v57
    v_cvt_pk_bf16_f32 v89, v58, v59
    v_cvt_pk_bf16_f32 v90, v60, v61
    v_cvt_pk_bf16_f32 v91, v62, v63
    s_waitcnt lgkmcnt(0)
    v_mfma_f32_32x32x16_bf16 v[72:87], v[52:55], a[108:111], v[72:87]
    ds_read_b128 v[108:111], v7 offset:17408
    ds_read_b128 v[112:115], v7 offset:18432
    ds_read_b128 v[116:119], v7 offset:19456
    v_mfma_f32_32x32x16_bf16 v[120:135], v[96:99], v[88:91], v[120:135]
    ds_read_b128 v[56:59], v9 offset:1792
    ds_read_b128 v[60:63], v9 offset:1808
    v_mfma_f32_32x32x16_bf16 v[136:151], v[100:103], v[88:91], v[136:151]
    v_mfma_f32_32x32x16_bf16 v[152:167], v[88:91], v[104:107], v[152:167]
    s_nop 3
    v_cvt_pk_bf16_f32 v92, v72, v73
    v_cvt_pk_bf16_f32 v93, v74, v75
    v_cvt_pk_bf16_f32 v94, v76, v77
    v_cvt_pk_bf16_f32 v95, v78, v79
    s_waitcnt vmcnt(10)
    s_barrier
    v_and_b32 v52, v44, v48
    v_and_b32 v53, v44, v49
    v_and_b32 v54, v44, v50
    v_and_b32 v55, v44, v51
    s_waitcnt lgkmcnt(0)
    s_nop 0
    v_mfma_f32_32x32x16_bf16 v[56:71], v[52:55], a[112:115], v[56:71]
    ds_read_b128 v[96:99], v7 offset:20480
    ds_read_b128 v[100:103], v7 offset:21504
    ds_read_b128 v[104:107], v7 offset:22528
    v_mfma_f32_32x32x16_bf16 v[120:135], v[108:111], v[92:95], v[120:135]
    ds_read_b128 v[72:75], v9 offset:1856
    ds_read_b128 v[76:79], v9 offset:1872
    v_mfma_f32_32x32x16_bf16 v[136:151], v[112:115], v[92:95], v[136:151]
    v_and_b32 v52, v45, v48
    v_and_b32 v53, v45, v49
    v_and_b32 v54, v45, v50
    v_and_b32 v55, v45, v51
    v_mfma_f32_32x32x16_bf16 v[152:167], v[92:95], v[116:119], v[152:167]
    v_cvt_pk_bf16_f32 v88, v56, v57
    v_cvt_pk_bf16_f32 v89, v58, v59
    v_cvt_pk_bf16_f32 v90, v60, v61
    v_cvt_pk_bf16_f32 v91, v62, v63
    s_waitcnt lgkmcnt(0)
    v_mfma_f32_32x32x16_bf16 v[72:87], v[52:55], a[116:119], v[72:87]
    ds_read_b128 v[108:111], v7 offset:23552
    ds_read_b128 v[112:115], v7 offset:24576
    ds_read_b128 v[116:119], v7 offset:25600
    v_mfma_f32_32x32x16_bf16 v[120:135], v[96:99], v[88:91], v[120:135]
    ds_read_b128 v[56:59], v9 offset:1920
    ds_read_b128 v[60:63], v9 offset:1936
    v_mfma_f32_32x32x16_bf16 v[136:151], v[100:103], v[88:91], v[136:151]
    v_and_b32 v52, v46, v48
    v_and_b32 v53, v46, v49
    v_and_b32 v54, v46, v50
    v_and_b32 v55, v46, v51
    v_mfma_f32_32x32x16_bf16 v[152:167], v[88:91], v[104:107], v[152:167]
    v_cvt_pk_bf16_f32 v92, v72, v73
    v_cvt_pk_bf16_f32 v93, v74, v75
    v_cvt_pk_bf16_f32 v94, v76, v77
    v_cvt_pk_bf16_f32 v95, v78, v79
    s_waitcnt lgkmcnt(0)
    v_mfma_f32_32x32x16_bf16 v[56:71], v[52:55], a[120:123], v[56:71]
    ds_read_b128 v[96:99], v7 offset:26624
    ds_read_b128 v[100:103], v7 offset:27648
    ds_read_b128 v[104:107], v7 offset:28672
    v_mfma_f32_32x32x16_bf16 v[120:135], v[108:111], v[92:95], v[120:135]
    ds_read_b128 v[72:75], v9 offset:1984
    ds_read_b128 v[76:79], v9 offset:2000
    v_mfma_f32_32x32x16_bf16 v[136:151], v[112:115], v[92:95], v[136:151]
    v_and_b32 v52, v47, v48
    v_and_b32 v53, v47, v49
    v_and_b32 v54, v47, v50
    v_and_b32 v55, v47, v51
    v_mfma_f32_32x32x16_bf16 v[152:167], v[92:95], v[116:119], v[152:167]
    v_cvt_pk_bf16_f32 v88, v56, v57
    v_cvt_pk_bf16_f32 v89, v58, v59
    v_cvt_pk_bf16_f32 v90, v60, v61
    v_cvt_pk_bf16_f32 v91, v62, v63
    s_waitcnt lgkmcnt(0)
    v_mfma_f32_32x32x16_bf16 v[72:87], v[52:55], a[124:127], v[72:87]
    ds_read_b128 v[108:111], v7 offset:29696
    ds_read_b128 v[112:115], v7 offset:30720
    ds_read_b128 v[116:119], v7 offset:31744
    v_mfma_f32_32x32x16_bf16 v[120:135], v[96:99], v[88:91], v[120:135]
    v_mfma_f32_32x32x16_bf16 v[136:151], v[100:103], v[88:91], v[136:151]
    v_mfma_f32_32x32x16_bf16 v[152:167], v[88:91], v[104:107], v[152:167]
    s_nop 5
    v_cvt_pk_bf16_f32 v92, v72, v73
    v_cvt_pk_bf16_f32 v93, v74, v75
    v_cvt_pk_bf16_f32 v94, v76, v77
    v_cvt_pk_bf16_f32 v95, v78, v79
    s_waitcnt lgkmcnt(0)
    s_nop 0
    v_mfma_f32_32x32x16_bf16 v[120:135], v[108:111], v[92:95], v[120:135]
    v_mfma_f32_32x32x16_bf16 v[136:151], v[112:115], v[92:95], v[136:151]
    v_mfma_f32_32x32x16_bf16 v[152:167], v[92:95], v[116:119], v[152:167]
    s_nop 9
    v_cvt_pk_bf16_f32 v16, v120, v121
    v_cvt_pk_bf16_f32 v17, v122, v123
    v_cvt_pk_bf16_f32 v18, v124, v125
    v_cvt_pk_bf16_f32 v19, v126, v127
    v_cvt_pk_bf16_f32 v20, v128, v129
    v_cvt_pk_bf16_f32 v21, v130, v131
    v_cvt_pk_bf16_f32 v22, v132, v133
    v_cvt_pk_bf16_f32 v23, v134, v135
    v_cvt_pk_bf16_f32 v24, v136, v137
    v_cvt_pk_bf16_f32 v25, v138, v139
    v_cvt_pk_bf16_f32 v26, v140, v141
    v_cvt_pk_bf16_f32 v27, v142, v143
    v_cvt_pk_bf16_f32 v28, v144, v145
    v_cvt_pk_bf16_f32 v29, v146, v147
    v_cvt_pk_bf16_f32 v30, v148, v149
    v_cvt_pk_bf16_f32 v31, v150, v151
    v_cvt_pk_bf16_f32 v32, v152, v153
    v_cvt_pk_bf16_f32 v33, v154, v155
    v_cvt_pk_bf16_f32 v34, v156, v157
    v_cvt_pk_bf16_f32 v35, v158, v159
    v_cvt_pk_bf16_f32 v36, v160, v161
    v_cvt_pk_bf16_f32 v37, v162, v163
    v_cvt_pk_bf16_f32 v38, v164, v165
    v_cvt_pk_bf16_f32 v39, v166, v167
    s_waitcnt vmcnt(8)
    v_mfma_f32_32x32x16_bf16 v[40:55], v[168:171], v[16:19], 0
    v_mfma_f32_32x32x16_bf16 v[56:71], v[172:175], v[20:23], 0
    v_mfma_f32_32x32x16_bf16 v[72:87], v[168:171], v[24:27], 0
    v_mfma_f32_32x32x16_bf16 v[88:103], v[172:175], v[28:31], 0
    s_lshl_b32 s43, s41, 16
    s_lshl_b32 s38, s40, 12
    s_add_u32 s43, s43, s38
    s_add_u32 s43, s43, 4194304
    s_nop 6
    v_max3_f32 v136, v72, v73, v74
    v_max3_f32 v137, v80, v81, v82
    v_max3_f32 v136, v136, v75, v76
    v_max3_f32 v137, v137, v83, v84
    v_max3_f32 v136, v136, v77, v78
    v_max3_f32 v137, v137, v85, v86
    v_max3_f32 v136, v136, v79, v87
    v_max_f32 v136, v136, v137
    v_mul_f32 v136, s36, v136
    v_pk_fma_f32 v[72:73], v[72:73], s[36:37], v[136:137] op_sel_hi:[1,1,0] neg_lo:[0,0,1] neg_hi:[0,0,1]
    v_pk_fma_f32 v[74:75], v[74:75], s[36:37], v[136:137] op_sel_hi:[1,1,0] neg_lo:[0,0,1] neg_hi:[0,0,1]
    v_pk_fma_f32 v[76:77], v[76:77], s[36:37], v[136:137] op_sel_hi:[1,1,0] neg_lo:[0,0,1] neg_hi:[0,0,1]
    v_pk_fma_f32 v[78:79], v[78:79], s[36:37], v[136:137] op_sel_hi:[1,1,0] neg_lo:[0,0,1] neg_hi:[0,0,1]
    v_pk_fma_f32 v[80:81], v[80:81], s[36:37], v[136:137] op_sel_hi:[1,1,0] neg_lo:[0,0,1] neg_hi:[0,0,1]
    v_pk_fma_f32 v[82:83], v[82:83], s[36:37], v[136:137] op_sel_hi:[1,1,0] neg_lo:[0,0,1] neg_hi:[0,0,1]
    v_pk_fma_f32 v[84:85], v[84:85], s[36:37], v[136:137] op_sel_hi:[1,1,0] neg_lo:[0,0,1] neg_hi:[0,0,1]
    v_pk_fma_f32 v[86:87], v[86:87], s[36:37], v[136:137] op_sel_hi:[1,1,0] neg_lo:[0,0,1] neg_hi:[0,0,1]
    v_exp_f32 v72, v72
    v_exp_f32 v73, v73
    v_exp_f32 v74, v74
    v_exp_f32 v75, v75
    v_exp_f32 v76, v76
    v_exp_f32 v77, v77
    v_exp_f32 v78, v78
    v_exp_f32 v79, v79
    v_exp_f32 v80, v80
    v_exp_f32 v81, v81
    v_exp_f32 v82, v82
    v_exp_f32 v83, v83
    v_exp_f32 v84, v84
    v_exp_f32 v85, v85
    v_exp_f32 v86, v86
    v_exp_f32 v87, v87
    v_pk_add_f32 v[138:139], v[72:73], v[74:75]
    v_pk_add_f32 v[136:137], v[76:77], v[78:79]
    v_pk_add_f32 v[138:139], v[138:139], v[80:81]
    v_pk_add_f32 v[136:137], v[136:137], v[82:83]
    v_pk_add_f32 v[138:139], v[138:139], v[84:85]
    v_pk_add_f32 v[136:137], v[136:137], v[86:87]
    v_pk_add_f32 v[138:139], v[138:139], v[136:137]
    v_add_f32 v138, v138, v139
    v_rcp_f32 v138, v138
    s_nop 0
    v_pk_mul_f32 v[72:73], v[72:73], v[138:139] op_sel_hi:[1,0]
    v_pk_mul_f32 v[74:75], v[74:75], v[138:139] op_sel_hi:[1,0]
    v_pk_mul_f32 v[76:77], v[76:77], v[138:139] op_sel_hi:[1,0]
    v_pk_mul_f32 v[78:79], v[78:79], v[138:139] op_sel_hi:[1,0]
    v_pk_mul_f32 v[80:81], v[80:81], v[138:139] op_sel_hi:[1,0]
    v_pk_mul_f32 v[82:83], v[82:83], v[138:139] op_sel_hi:[1,0]
    v_pk_mul_f32 v[84:85], v[84:85], v[138:139] op_sel_hi:[1,0]
    v_pk_mul_f32 v[86:87], v[86:87], v[138:139] op_sel_hi:[1,0]
    v_cvt_pk_bf16_f32 v120, v72, v73
    v_cvt_pk_bf16_f32 v121, v74, v75
    v_cvt_pk_bf16_f32 v122, v76, v77
    v_cvt_pk_bf16_f32 v123, v78, v79
    v_cvt_pk_bf16_f32 v124, v80, v81
    v_cvt_pk_bf16_f32 v125, v82, v83
    v_cvt_pk_bf16_f32 v126, v84, v85
    v_cvt_pk_bf16_f32 v127, v86, v87
    v_mfma_f32_32x32x16_bf16 v[228:243], v[120:123], v[176:179], 0
    s_nop 0
    v_mfma_f32_32x32x16_bf16 v[228:243], v[124:127], v[180:183], v[228:243]
    s_nop 11
    v_cvt_pk_bf16_f32 v140, v228, v229
    v_cvt_pk_bf16_f32 v141, v230, v231
    v_cvt_pk_bf16_f32 v142, v232, v233
    v_cvt_pk_bf16_f32 v143, v234, v235
    v_cvt_pk_bf16_f32 v144, v236, v237
    v_cvt_pk_bf16_f32 v145, v238, v239
    v_cvt_pk_bf16_f32 v146, v240, v241
    v_cvt_pk_bf16_f32 v147, v242, v243
    v_mfma_f32_32x32x16_bf16 v[72:87], v[32:35], v[140:143], 0
    s_nop 0
    v_mfma_f32_32x32x16_bf16 v[72:87], v[36:39], v[144:147], v[72:87]
    v_mfma_f32_32x32x16_bf16 v[188:203], v[184:187], v[140:143], 0
    v_mfma_f32_32x32x16_bf16 v[188:203], v[184:187], v[144:147], v[188:203]
    v_max3_f32 v136, v88, v89, v90
    v_max3_f32 v137, v96, v97, v98
    v_max3_f32 v136, v136, v91, v92
    v_max3_f32 v137, v137, v99, v100
    v_max3_f32 v136, v136, v93, v94
    v_max3_f32 v137, v137, v101, v102
    v_max3_f32 v136, v136, v95, v103
    v_max_f32 v136, v136, v137
    v_mul_f32 v136, s36, v136
    v_pk_fma_f32 v[88:89], v[88:89], s[36:37], v[136:137] op_sel_hi:[1,1,0] neg_lo:[0,0,1] neg_hi:[0,0,1]
    v_pk_fma_f32 v[90:91], v[90:91], s[36:37], v[136:137] op_sel_hi:[1,1,0] neg_lo:[0,0,1] neg_hi:[0,0,1]
    v_pk_fma_f32 v[92:93], v[92:93], s[36:37], v[136:137] op_sel_hi:[1,1,0] neg_lo:[0,0,1] neg_hi:[0,0,1]
    v_pk_fma_f32 v[94:95], v[94:95], s[36:37], v[136:137] op_sel_hi:[1,1,0] neg_lo:[0,0,1] neg_hi:[0,0,1]
    v_pk_fma_f32 v[96:97], v[96:97], s[36:37], v[136:137] op_sel_hi:[1,1,0] neg_lo:[0,0,1] neg_hi:[0,0,1]
    v_pk_fma_f32 v[98:99], v[98:99], s[36:37], v[136:137] op_sel_hi:[1,1,0] neg_lo:[0,0,1] neg_hi:[0,0,1]
    v_pk_fma_f32 v[100:101], v[100:101], s[36:37], v[136:137] op_sel_hi:[1,1,0] neg_lo:[0,0,1] neg_hi:[0,0,1]
    v_pk_fma_f32 v[102:103], v[102:103], s[36:37], v[136:137] op_sel_hi:[1,1,0] neg_lo:[0,0,1] neg_hi:[0,0,1]
    v_exp_f32 v88, v88
    v_exp_f32 v89, v89
    v_exp_f32 v90, v90
    v_exp_f32 v91, v91
    v_exp_f32 v92, v92
    v_exp_f32 v93, v93
    v_exp_f32 v94, v94
    v_exp_f32 v95, v95
    v_exp_f32 v96, v96
    v_exp_f32 v97, v97
    v_exp_f32 v98, v98
    v_exp_f32 v99, v99
    v_exp_f32 v100, v100
    v_exp_f32 v101, v101
    v_exp_f32 v102, v102
    v_exp_f32 v103, v103
    v_pk_add_f32 v[138:139], v[88:89], v[90:91]
    v_pk_add_f32 v[136:137], v[92:93], v[94:95]
    v_pk_add_f32 v[138:139], v[138:139], v[96:97]
    v_pk_add_f32 v[136:137], v[136:137], v[98:99]
    v_pk_add_f32 v[138:139], v[138:139], v[100:101]
    v_pk_add_f32 v[136:137], v[136:137], v[102:103]
    v_pk_add_f32 v[138:139], v[138:139], v[136:137]
    v_add_f32 v138, v138, v139
    v_rcp_f32 v138, v138
    s_nop 0
    v_pk_mul_f32 v[88:89], v[88:89], v[138:139] op_sel_hi:[1,0]
    v_pk_mul_f32 v[90:91], v[90:91], v[138:139] op_sel_hi:[1,0]
    v_pk_mul_f32 v[92:93], v[92:93], v[138:139] op_sel_hi:[1,0]
    v_pk_mul_f32 v[94:95], v[94:95], v[138:139] op_sel_hi:[1,0]
    v_pk_mul_f32 v[96:97], v[96:97], v[138:139] op_sel_hi:[1,0]
    v_pk_mul_f32 v[98:99], v[98:99], v[138:139] op_sel_hi:[1,0]
    v_pk_mul_f32 v[100:101], v[100:101], v[138:139] op_sel_hi:[1,0]
    v_pk_mul_f32 v[102:103], v[102:103], v[138:139] op_sel_hi:[1,0]
    v_cvt_pk_bf16_f32 v128, v88, v89
    v_cvt_pk_bf16_f32 v129, v90, v91
    v_cvt_pk_bf16_f32 v130, v92, v93
    v_cvt_pk_bf16_f32 v131, v94, v95
    v_cvt_pk_bf16_f32 v132, v96, v97
    v_cvt_pk_bf16_f32 v133, v98, v99
    v_cvt_pk_bf16_f32 v134, v100, v101
    v_cvt_pk_bf16_f32 v135, v102, v103
    v_mfma_f32_32x32x16_bf16 v[228:243], v[128:131], v[176:179], 0
    s_nop 0
    v_mfma_f32_32x32x16_bf16 v[228:243], v[132:135], v[180:183], v[228:243]
    s_nop 11
    v_cvt_pk_bf16_f32 v140, v228, v229
    v_cvt_pk_bf16_f32 v141, v230, v231
    v_cvt_pk_bf16_f32 v142, v232, v233
    v_cvt_pk_bf16_f32 v143, v234, v235
    v_cvt_pk_bf16_f32 v144, v236, v237
    v_cvt_pk_bf16_f32 v145, v238, v239
    v_cvt_pk_bf16_f32 v146, v240, v241
    v_cvt_pk_bf16_f32 v147, v242, v243
    v_mfma_f32_32x32x16_bf16 v[88:103], v[32:35], v[140:143], 0
    s_nop 0
    v_mfma_f32_32x32x16_bf16 v[88:103], v[36:39], v[144:147], v[88:103]
    v_mfma_f32_32x32x16_bf16 v[204:219], v[184:187], v[140:143], 0
    v_mfma_f32_32x32x16_bf16 v[204:219], v[184:187], v[144:147], v[204:219]
    s_waitcnt vmcnt(0)
    s_barrier
    v_bfe_u32 v4, v1, 2, 2
    v_mul_u32_u24 v4, 576, v4
    v_and_b32 v5, 3, v1
    v_lshl_add_u32 v4, v5, 2, v4
    s_mul_i32 s38, s30, 4608
    v_add_u32 v4, s38, v4
    v_bfe_u32 v5, v1, 4, 1
    v_lshl_add_u32 v8, v5, 4, v4
    v_lshl_add_u32 v4, v5, 8, v4
    v_lshrrev_b32 v5, 5, v1
    v_lshl_add_u32 v4, v5, 6, v4
    ds_write_b32 v4, v72 offset:0
    ds_write_b32 v4, v73 offset:16
    ds_write_b32 v4, v74 offset:32
    ds_write_b32 v4, v75 offset:48
    ds_write_b32 v4, v76 offset:128
    ds_write_b32 v4, v77 offset:144
    ds_write_b32 v4, v78 offset:160
    ds_write_b32 v4, v79 offset:176
    ds_write_b32 v8, v188 offset:512
    ds_write_b32 v4, v96 offset:2304
    ds_write_b32 v4, v97 offset:2320
    ds_write_b32 v4, v98 offset:2336
    ds_write_b32 v4, v99 offset:2352
    ds_write_b32 v4, v100 offset:2432
    ds_write_b32 v4, v101 offset:2448
    ds_write_b32 v4, v102 offset:2464
    ds_write_b32 v4, v103 offset:2480
    ds_write_b32 v8, v204 offset:2816
    v_lshrrev_b32 v3, 7, v0
    v_mul_u32_u24 v3, 576, v3
    v_and_b32 v4, 127, v0
    v_lshl_add_u32 v3, v4, 2, v3
    s_waitcnt lgkmcnt(0)
    s_barrier
    ds_read_b32 v148, v3 offset:0
    ds_read_b32 v149, v3 offset:4608
    ds_read_b32 v150, v3 offset:9216
    ds_read_b32 v151, v3 offset:13824
    ds_read_b32 v152, v3 offset:1152
    ds_read_b32 v153, v3 offset:5760
    ds_read_b32 v154, v3 offset:10368
    ds_read_b32 v155, v3 offset:14976
    ds_read_b32 v156, v3 offset:2304
    ds_read_b32 v157, v3 offset:6912
    ds_read_b32 v158, v3 offset:11520
    ds_read_b32 v159, v3 offset:16128
    ds_read_b32 v160, v3 offset:3456
    ds_read_b32 v161, v3 offset:8064
    ds_read_b32 v162, v3 offset:12672
    ds_read_b32 v163, v3 offset:17280
    v_lshrrev_b32 v4, 5, v1
    v_mul_u32_u24 v4, 2304, v4
    v_bfe_u32 v5, v1, 3, 2
    v_mul_u32_u24 v5, 576, v5
    v_add_u32 v4, v4, v5
    v_and_b32 v5, 7, v1
    v_lshl_add_u32 v4, v5, 2, v4
    v_add_u32 v4, 512, v4
    ds_read_b32 v164, v4 offset:0
    ds_read_b32 v165, v4 offset:4608
    ds_read_b32 v166, v4 offset:9216
    ds_read_b32 v167, v4 offset:13824
    s_mul_i32 s38, s40, 4608
    s_add_u32 s38, s38, 3801088
    s_waitcnt lgkmcnt(15)
    v_add_f32 v148, v148, v149
    v_add_f32 v150, v150, v151
    v_add_f32 v148, v148, v150
    buffer_atomic_add_f32 v148, v3, s[32:35], s38 offen offset:0
    s_waitcnt lgkmcnt(12)
    v_add_f32 v152, v152, v153
    v_add_f32 v154, v154, v155
    v_add_f32 v152, v152, v154
    buffer_atomic_add_f32 v152, v3, s[32:35], s38 offen offset:1152
    s_waitcnt lgkmcnt(8)
    v_add_f32 v156, v156, v157
    v_add_f32 v158, v158, v159
    v_add_f32 v156, v156, v158
    buffer_atomic_add_f32 v156, v3, s[32:35], s38 offen offset:2304
    s_waitcnt lgkmcnt(4)
    v_add_f32 v160, v160, v161
    v_add_f32 v162, v162, v163
    v_add_f32 v160, v160, v162
    buffer_atomic_add_f32 v160, v3, s[32:35], s38 offen offset:3456
    s_waitcnt lgkmcnt(0)
    v_add_f32 v164, v164, v165
    v_add_f32 v166, v166, v167
    v_add_f32 v164, v164, v166
    s_cmp_lg_u32 s30, 0
    s_cbranch_scc1 p1_noz
    buffer_atomic_add_f32 v164, v4, s[32:35], s38 offen
p1_noz:
    v_max3_f32 v136, v40, v41, v42
    v_max3_f32 v137, v48, v49, v50
    v_max3_f32 v136, v136, v43, v44
    v_max3_f32 v137, v137, v51, v52
    v_max3_f32 v136, v136, v45, v46
    v_max3_f32 v137, v137, v53, v54
    v_max3_f32 v136, v136, v47, v55
    v_max_f32 v136, v136, v137
    v_mul_f32 v136, s36, v136
    v_pk_fma_f32 v[40:41], v[40:41], s[36:37], v[136:137] op_sel_hi:[1,1,0] neg_lo:[0,0,1] neg_hi:[0,0,1]
    v_pk_fma_f32 v[42:43], v[42:43], s[36:37], v[136:137] op_sel_hi:[1,1,0] neg_lo:[0,0,1] neg_hi:[0,0,1]
    v_pk_fma_f32 v[44:45], v[44:45], s[36:37], v[136:137] op_sel_hi:[1,1,0] neg_lo:[0,0,1] neg_hi:[0,0,1]
    v_pk_fma_f32 v[46:47], v[46:47], s[36:37], v[136:137] op_sel_hi:[1,1,0] neg_lo:[0,0,1] neg_hi:[0,0,1]
    v_pk_fma_f32 v[48:49], v[48:49], s[36:37], v[136:137] op_sel_hi:[1,1,0] neg_lo:[0,0,1] neg_hi:[0,0,1]
    v_pk_fma_f32 v[50:51], v[50:51], s[36:37], v[136:137] op_sel_hi:[1,1,0] neg_lo:[0,0,1] neg_hi:[0,0,1]
    v_pk_fma_f32 v[52:53], v[52:53], s[36:37], v[136:137] op_sel_hi:[1,1,0] neg_lo:[0,0,1] neg_hi:[0,0,1]
    v_pk_fma_f32 v[54:55], v[54:55], s[36:37], v[136:137] op_sel_hi:[1,1,0] neg_lo:[0,0,1] neg_hi:[0,0,1]
    v_exp_f32 v40, v40
    v_exp_f32 v41, v41
    v_exp_f32 v42, v42
    v_exp_f32 v43, v43
    v_exp_f32 v44, v44
    v_exp_f32 v45, v45
    v_exp_f32 v46, v46
    v_exp_f32 v47, v47
    v_exp_f32 v48, v48
    v_exp_f32 v49, v49
    v_exp_f32 v50, v50
    v_exp_f32 v51, v51
    v_exp_f32 v52, v52
    v_exp_f32 v53, v53
    v_exp_f32 v54, v54
    v_exp_f32 v55, v55
    v_pk_add_f32 v[138:139], v[40:41], v[42:43]
    v_pk_add_f32 v[136:137], v[44:45], v[46:47]
    v_pk_add_f32 v[138:139], v[138:139], v[48:49]
    v_pk_add_f32 v[136:137], v[136:137], v[50:51]
    v_pk_add_f32 v[138:139], v[138:139], v[52:53]
    v_pk_add_f32 v[136:137], v[136:137], v[54:55]
    v_pk_add_f32 v[138:139], v[138:139], v[136:137]
    v_add_f32 v138, v138, v139
    v_rcp_f32 v138, v138
    s_nop 0
    v_pk_mul_f32 v[40:41], v[40:41], v[138:139] op_sel_hi:[1,0]
    v_pk_mul_f32 v[42:43], v[42:43], v[138:139] op_sel_hi:[1,0]
    v_pk_mul_f32 v[44:45], v[44:45], v[138:139] op_sel_hi:[1,0]
    v_pk_mul_f32 v[46:47], v[46:47], v[138:139] op_sel_hi:[1,0]
    v_pk_mul_f32 v[48:49], v[48:49], v[138:139] op_sel_hi:[1,0]
    v_pk_mul_f32 v[50:51], v[50:51], v[138:139] op_sel_hi:[1,0]
    v_pk_mul_f32 v[52:53], v[52:53], v[138:139] op_sel_hi:[1,0]
    v_pk_mul_f32 v[54:55], v[54:55], v[138:139] op_sel_hi:[1,0]
    v_cvt_pk_bf16_f32 v104, v40, v41
    v_cvt_pk_bf16_f32 v105, v42, v43
    v_cvt_pk_bf16_f32 v106, v44, v45
    v_cvt_pk_bf16_f32 v107, v46, v47
    v_cvt_pk_bf16_f32 v108, v48, v49
    v_cvt_pk_bf16_f32 v109, v50, v51
    v_cvt_pk_bf16_f32 v110, v52, v53
    v_cvt_pk_bf16_f32 v111, v54, v55
    buffer_store_dwordx4 v[104:107], v2, s[32:35], s43 offen offset:0 sc1
    buffer_store_dwordx4 v[108:111], v2, s[32:35], s43 offen offset:1024 sc1
    v_max3_f32 v136, v56, v57, v58
    v_max3_f32 v137, v64, v65, v66
    v_max3_f32 v136, v136, v59, v60
    v_max3_f32 v137, v137, v67, v68
    v_max3_f32 v136, v136, v61, v62
    v_max3_f32 v137, v137, v69, v70
    v_max3_f32 v136, v136, v63, v71
    v_max_f32 v136, v136, v137
    v_mul_f32 v136, s36, v136
    v_pk_fma_f32 v[56:57], v[56:57], s[36:37], v[136:137] op_sel_hi:[1,1,0] neg_lo:[0,0,1] neg_hi:[0,0,1]
    v_pk_fma_f32 v[58:59], v[58:59], s[36:37], v[136:137] op_sel_hi:[1,1,0] neg_lo:[0,0,1] neg_hi:[0,0,1]
    v_pk_fma_f32 v[60:61], v[60:61], s[36:37], v[136:137] op_sel_hi:[1,1,0] neg_lo:[0,0,1] neg_hi:[0,0,1]
    v_pk_fma_f32 v[62:63], v[62:63], s[36:37], v[136:137] op_sel_hi:[1,1,0] neg_lo:[0,0,1] neg_hi:[0,0,1]
    v_pk_fma_f32 v[64:65], v[64:65], s[36:37], v[136:137] op_sel_hi:[1,1,0] neg_lo:[0,0,1] neg_hi:[0,0,1]
    v_pk_fma_f32 v[66:67], v[66:67], s[36:37], v[136:137] op_sel_hi:[1,1,0] neg_lo:[0,0,1] neg_hi:[0,0,1]
    v_pk_fma_f32 v[68:69], v[68:69], s[36:37], v[136:137] op_sel_hi:[1,1,0] neg_lo:[0,0,1] neg_hi:[0,0,1]
    v_pk_fma_f32 v[70:71], v[70:71], s[36:37], v[136:137] op_sel_hi:[1,1,0] neg_lo:[0,0,1] neg_hi:[0,0,1]
    v_exp_f32 v56, v56
    v_exp_f32 v57, v57
    v_exp_f32 v58, v58
    v_exp_f32 v59, v59
    v_exp_f32 v60, v60
    v_exp_f32 v61, v61
    v_exp_f32 v62, v62
    v_exp_f32 v63, v63
    v_exp_f32 v64, v64
    v_exp_f32 v65, v65
    v_exp_f32 v66, v66
    v_exp_f32 v67, v67
    v_exp_f32 v68, v68
    v_exp_f32 v69, v69
    v_exp_f32 v70, v70
    v_exp_f32 v71, v71
    v_pk_add_f32 v[138:139], v[56:57], v[58:59]
    v_pk_add_f32 v[136:137], v[60:61], v[62:63]
    v_pk_add_f32 v[138:139], v[138:139], v[64:65]
    v_pk_add_f32 v[136:137], v[136:137], v[66:67]
    v_pk_add_f32 v[138:139], v[138:139], v[68:69]
    v_pk_add_f32 v[136:137], v[136:137], v[70:71]
    v_pk_add_f32 v[138:139], v[138:139], v[136:137]
    v_add_f32 v138, v138, v139
    v_rcp_f32 v138, v138
    s_nop 0
    v_pk_mul_f32 v[56:57], v[56:57], v[138:139] op_sel_hi:[1,0]
    v_pk_mul_f32 v[58:59], v[58:59], v[138:139] op_sel_hi:[1,0]
    v_pk_mul_f32 v[60:61], v[60:61], v[138:139] op_sel_hi:[1,0]
    v_pk_mul_f32 v[62:63], v[62:63], v[138:139] op_sel_hi:[1,0]
    v_pk_mul_f32 v[64:65], v[64:65], v[138:139] op_sel_hi:[1,0]
    v_pk_mul_f32 v[66:67], v[66:67], v[138:139] op_sel_hi:[1,0]
    v_pk_mul_f32 v[68:69], v[68:69], v[138:139] op_sel_hi:[1,0]
    v_pk_mul_f32 v[70:71], v[70:71], v[138:139] op_sel_hi:[1,0]
    v_cvt_pk_bf16_f32 v112, v56, v57
    v_cvt_pk_bf16_f32 v113, v58, v59
    v_cvt_pk_bf16_f32 v114, v60, v61
    v_cvt_pk_bf16_f32 v115, v62, v63
    v_cvt_pk_bf16_f32 v116, v64, v65
    v_cvt_pk_bf16_f32 v117, v66, v67
    v_cvt_pk_bf16_f32 v118, v68, v69
    v_cvt_pk_bf16_f32 v119, v70, v71
    buffer_store_dwordx4 v[112:115], v2, s[32:35], s43 offen offset:2048 sc1
    buffer_store_dwordx4 v[116:119], v2, s[32:35], s43 offen offset:3072 sc1
    s_lshl_b32 s99, s40, 11
    s_add_u32 s99, s99, 3952640
    s_mov_b32 s63, s58
    v_bfe_u32 v221, v1, 2, 2
    v_lshrrev_b32 v222, 5, v1
    v_lshl_add_u32 v224, v222, 3, v221
    v_lshlrev_b32 v224, 7, v224
    v_lshrrev_b32 v221, 1, v221
    v_lshlrev_b32 v221, 2, v221
    v_bfe_u32 v222, v1, 1, 1
    v_xor_b32 v221, v221, v222
    s_lshl_b32 s96, s30, 1
    v_xor_b32 v221, s96, v221
    v_lshl_add_u32 v224, v221, 4, v224
    v_and_b32 v222, 1, v1
    v_lshl_add_u32 v224, v222, 3, v224
    v_bfe_u32 v222, v1, 4, 1
    v_lshl_add_u32 v224, v222, 11, v224
    v_add_u32 v224, 100352, v224
    ds_read_b64_tr_b16 v[228:229], v224 offset:0
    ds_read_b64_tr_b16 v[230:231], v224 offset:512
    ds_read_b64_tr_b16 v[232:233], v224 offset:4096
    ds_read_b64_tr_b16 v[234:235], v224 offset:4608
    ds_read_b64_tr_b16 v[236:237], v224 offset:8192
    ds_read_b64_tr_b16 v[238:239], v224 offset:8704
    ds_read_b64_tr_b16 v[240:241], v224 offset:12288
    ds_read_b64_tr_b16 v[242:243], v224 offset:12800
    v_lshrrev_b32 v222, 5, v1
    v_lshlrev_b32 v223, 5, v222
    v_add_u32 v223, 124928, v223
    v_lshlrev_b32 v225, 4, v222
    v_add_u32 v225, 125184, v225
    ds_read_b128 v[56:59], v223 offset:0
    ds_read_b128 v[60:63], v223 offset:16
    ds_read_b128 v[88:91], v225 offset:0
    ds_read_b128 v[64:67], v223 offset:64
    ds_read_b128 v[68:71], v223 offset:80
    ds_read_b128 v[92:95], v225 offset:32
    ds_read_b128 v[72:75], v223 offset:128
    ds_read_b128 v[76:79], v223 offset:144
    ds_read_b128 v[96:99], v225 offset:64
    ds_read_b128 v[80:83], v223 offset:192
    ds_read_b128 v[84:87], v223 offset:208
    ds_read_b128 v[100:103], v225 offset:96
    s_lshl_b32 s96, s58, 2
    s_add_u32 s96, s96, s30
    s_mul_i32 s97, s96, 9363
    s_lshr_b32 s97, s97, 16
    s_mul_i32 s98, s97, 7
    s_sub_u32 s98, s96, s98
    s_lshl_b32 s97, s97, 5
    s_lshl_b32 s59, s57, 2
    s_add_u32 s97, s97, s59
    s_mul_i32 s97, s97, 7
    s_add_u32 s97, s97, s98
    s_lshl_b32 s97, s97, 10
    s_add_u32 s97, s97, 13631488
    s_lshl_b32 s96, s96, 8
    s_add_u32 s96, s96, 3874816
    s_cmp_ge_u32 s2, 224
    s_cselect_b32 s97, 0x7f000000, s97
    s_cmp_ge_u32 s2, 224
    s_cselect_b32 s96, 0x7f000000, s96
    v_and_b32 v136, 31, v1
    v_cmp_eq_u32 vcc, 0, v136
    v_mov_b32 v137, 0x3f803f80
    s_nop 0
    v_cndmask_b32 v32, 0, v137, vcc
    v_cndmask_b32 v33, 0, v137, vcc
    v_cndmask_b32 v34, 0, v137, vcc
    v_cndmask_b32 v35, 0, v137, vcc
    v_cmp_eq_u32 vcc, 1, v136
    s_nop 1
    v_cndmask_b32 v136, 0, -1, vcc
    s_waitcnt lgkmcnt(0)
    v_and_b32 v88, v88, v136
    v_and_b32 v89, v89, v136
    v_and_b32 v90, v90, v136
    v_and_b32 v91, v91, v136
    v_and_b32 v92, v92, v136
    v_and_b32 v93, v93, v136
    v_and_b32 v94, v94, v136
    v_and_b32 v95, v95, v136
    v_and_b32 v96, v96, v136
    v_and_b32 v97, v97, v136
    v_and_b32 v98, v98, v136
    v_and_b32 v99, v99, v136
    v_and_b32 v100, v100, v136
    v_and_b32 v101, v101, v136
    v_and_b32 v102, v102, v136
    v_and_b32 v103, v103, v136
    v_mfma_f32_32x32x16_bf16 v[188:203], v[88:91], v[228:231], 0
    v_lshlrev_b32 v136, 16, v228
    v_and_b32 v137, 0xffff0000, v228
    v_lshlrev_b32 v138, 16, v229
    v_and_b32 v139, 0xffff0000, v229
    v_lshlrev_b32 v140, 16, v230
    v_and_b32 v141, 0xffff0000, v230
    v_lshlrev_b32 v142, 16, v231
    v_and_b32 v143, 0xffff0000, v231
    v_pk_mul_f32 v[136:137], v[136:137], v[56:57]
    v_pk_mul_f32 v[138:139], v[138:139], v[58:59]
    v_pk_mul_f32 v[140:141], v[140:141], v[60:61]
    v_pk_mul_f32 v[142:143], v[142:143], v[62:63]
    v_cvt_pk_bf16_f32 v228, v136, v137
    v_cvt_pk_bf16_f32 v229, v138, v139
    v_cvt_pk_bf16_f32 v230, v140, v141
    v_cvt_pk_bf16_f32 v231, v142, v143
    s_nop 1
    v_mfma_f32_32x32x16_bf16 v[16:31], v[32:35], v[228:231], 0
    v_mfma_f32_32x32x16_bf16 v[188:203], v[92:95], v[232:235], v[188:203]
    v_lshlrev_b32 v136, 16, v232
    v_and_b32 v137, 0xffff0000, v232
    v_lshlrev_b32 v138, 16, v233
    v_and_b32 v139, 0xffff0000, v233
    v_lshlrev_b32 v140, 16, v234
    v_and_b32 v141, 0xffff0000, v234
    v_lshlrev_b32 v142, 16, v235
    v_and_b32 v143, 0xffff0000, v235
    v_pk_mul_f32 v[136:137], v[136:137], v[64:65]
    v_pk_mul_f32 v[138:139], v[138:139], v[66:67]
    v_pk_mul_f32 v[140:141], v[140:141], v[68:69]
    v_pk_mul_f32 v[142:143], v[142:143], v[70:71]
    v_cvt_pk_bf16_f32 v232, v136, v137
    v_cvt_pk_bf16_f32 v233, v138, v139
    v_cvt_pk_bf16_f32 v234, v140, v141
    v_cvt_pk_bf16_f32 v235, v142, v143
    s_nop 1
    v_mfma_f32_32x32x16_bf16 v[16:31], v[32:35], v[232:235], v[16:31]
    v_mfma_f32_32x32x16_bf16 v[188:203], v[96:99], v[236:239], v[188:203]
    v_lshlrev_b32 v136, 16, v236
    v_and_b32 v137, 0xffff0000, v236
    v_lshlrev_b32 v138, 16, v237
    v_and_b32 v139, 0xffff0000, v237
    v_lshlrev_b32 v140, 16, v238
    v_and_b32 v141, 0xffff0000, v238
    v_lshlrev_b32 v142, 16, v239
    v_and_b32 v143, 0xffff0000, v239
    v_pk_mul_f32 v[136:137], v[136:137], v[72:73]
    v_pk_mul_f32 v[138:139], v[138:139], v[74:75]
    v_pk_mul_f32 v[140:141], v[140:141], v[76:77]
    v_pk_mul_f32 v[142:143], v[142:143], v[78:79]
    v_cvt_pk_bf16_f32 v236, v136, v137
    v_cvt_pk_bf16_f32 v237, v138, v139
    v_cvt_pk_bf16_f32 v238, v140, v141
    v_cvt_pk_bf16_f32 v239, v142, v143
    s_nop 1
    v_mfma_f32_32x32x16_bf16 v[16:31], v[32:35], v[236:239], v[16:31]
    v_mfma_f32_32x32x16_bf16 v[188:203], v[100:103], v[240:243], v[188:203]
    v_lshlrev_b32 v136, 16, v240
    v_and_b32 v137, 0xffff0000, v240
    v_lshlrev_b32 v138, 16, v241
    v_and_b32 v139, 0xffff0000, v241
    v_lshlrev_b32 v140, 16, v242
    v_and_b32 v141, 0xffff0000, v242
    v_lshlrev_b32 v142, 16, v243
    v_and_b32 v143, 0xffff0000, v243
    v_pk_mul_f32 v[136:137], v[136:137], v[80:81]
    v_pk_mul_f32 v[138:139], v[138:139], v[82:83]
    v_pk_mul_f32 v[140:141], v[140:141], v[84:85]
    v_pk_mul_f32 v[142:143], v[142:143], v[86:87]
    v_cvt_pk_bf16_f32 v240, v136, v137
    v_cvt_pk_bf16_f32 v241, v138, v139
    v_cvt_pk_bf16_f32 v242, v140, v141
    v_cvt_pk_bf16_f32 v243, v142, v143
    s_nop 1
    v_mfma_f32_32x32x16_bf16 v[16:31], v[32:35], v[240:243], v[16:31]
    s_nop 11
    v_permlane32_swap_b32 v16, v189
    v_mov_b32 v246, v16
    v_lshlrev_b32 v221, 2, v1
    s_waitcnt vmcnt(0)
    s_barrier
    s_cmp_lg_u32 s30, 0
    s_cbranch_scc1 s1a_skip
    v_lshlrev_b32 v10, 8, v1
    v_mov_b32 v11, 1
    s_mov_b64 exec, 0xff
    buffer_atomic_add v11, v10, s[32:35], s99 offen
    s_mov_b64 exec, -1
s1a_skip:
    s_and_b32 s46, s2, 7
    s_lshr_b32 s47, s2, 3
    s_lshl_b32 s44, s46, 2
    s_lshr_b32 s45, s47, 3
    s_add_u32 s44, s44, s45
    s_and_b32 s45, s47, 7
    s_mov_b32 s36, s10
    s_and_b32 s37, s11, 0xffff
    s_mov_b32 s38, 524288
    s_mov_b32 s39, 0x20000
    v_lshrrev_b32 v3, 3, v1
    v_and_b32 v4, 7, v1
    v_bfe_u32 v5, v3, 1, 1
    v_lshlrev_b32 v5, 2, v5
    v_xor_b32 v4, v4, v5
    v_mul_u32_u24 v3, 1024, v3
    v_lshl_add_u32 v3, v4, 4, v3
    s_lshl_b32 s40, s30, 14
    s_add_u32 s40, s40, 32768
    s_lshl_b32 s41, s30, 17
    s_lshl_b32 s42, s45, 7
    s_add_u32 s41, s41, s42
    s_add_u32 m0, s40, 0
    s_add_u32 s42, s41, 0
    buffer_load_dwordx4 v3, s[36:39], s42 offen lds
    s_add_u32 m0, s40, 1024
    s_add_u32 s42, s41, 8192
    buffer_load_dwordx4 v3, s[36:39], s42 offen lds
    s_add_u32 m0, s40, 2048
    s_add_u32 s42, s41, 16384
    buffer_load_dwordx4 v3, s[36:39], s42 offen lds
    s_add_u32 m0, s40, 3072
    s_add_u32 s42, s41, 24576
    buffer_load_dwordx4 v3, s[36:39], s42 offen lds
    s_add_u32 m0, s40, 4096
    s_add_u32 s42, s41, 32768
    buffer_load_dwordx4 v3, s[36:39], s42 offen lds
    s_add_u32 m0, s40, 5120
    s_add_u32 s42, s41, 40960
    buffer_load_dwordx4 v3, s[36:39], s42 offen lds
    s_add_u32 m0, s40, 6144
    s_add_u32 s42, s41, 49152
    buffer_load_dwordx4 v3, s[36:39], s42 offen lds
    s_add_u32 m0, s40, 7168
    s_add_u32 s42, s41, 57344
    buffer_load_dwordx4 v3, s[36:39], s42 offen lds
    s_add_u32 m0, s40, 8192
    s_add_u32 s42, s41, 65536
    buffer_load_dwordx4 v3, s[36:39], s42 offen lds
    s_add_u32 m0, s40, 9216
    s_add_u32 s42, s41, 73728
    buffer_load_dwordx4 v3, s[36:39], s42 offen lds
    s_add_u32 m0, s40, 10240
    s_add_u32 s42, s41, 81920
    buffer_load_dwordx4 v3, s[36:39], s42 offen lds
    s_add_u32 m0, s40, 11264
    s_add_u32 s42, s41, 90112
    buffer_load_dwordx4 v3, s[36:39], s42 offen lds
    s_add_u32 m0, s40, 12288
    s_add_u32 s42, s41, 98304
    buffer_load_dwordx4 v3, s[36:39], s42 offen lds
    s_add_u32 m0, s40, 13312
    s_add_u32 s42, s41, 106496
    buffer_load_dwordx4 v3, s[36:39], s42 offen lds
    s_add_u32 m0, s40, 14336
    s_add_u32 s42, s41, 114688
    buffer_load_dwordx4 v3, s[36:39], s42 offen lds
    s_add_u32 m0, s40, 15360
    s_add_u32 s42, s41, 122880
    buffer_load_dwordx4 v3, s[36:39], s42 offen lds
    v_bfe_u32 v5, v1, 2, 2
    v_lshrrev_b32 v6, 5, v1
    v_lshl_add_u32 v4, v6, 2, v5
    v_lshlrev_b32 v4, 7, v4
    v_lshrrev_b32 v5, 1, v5
    v_lshlrev_b32 v5, 2, v5
    v_bfe_u32 v6, v1, 4, 1
    v_lshlrev_b32 v6, 1, v6
    v_xor_b32 v5, v5, v6
    v_bfe_u32 v6, v1, 1, 1
    v_xor_b32 v5, v5, v6
    v_lshl_add_u32 v4, v5, 4, v4
    v_and_b32 v6, 1, v1
    v_lshl_add_u32 v4, v6, 3, v4
    v_add_u32 v4, s40, v4
    v_xor_b32 v5, 64, v4
    s_and_b32 s60, s2, 7
    s_lshl_b32 s60, s60, 8
    v_lshlrev_b32 v12, 11, v1
    v_add_u32 v12, 3952640, v12
    v_add_u32 v12, s60, v12
    v_mov_b32 v13, 16
    s_nop 1
    s_cmp_lg_u32 s30, 0
    s_cbranch_scc1 s1w_w
    s_mov_b32 s61, 0
    s_mov_b64 exec, 65535
s1w_poll:
    buffer_load_dword v10, v12, s[32:35], 0 offen sc1
    s_add_u32 s61, s61, 1
    s_waitcnt vmcnt(0)
    v_cmp_ne_u32 vcc, v10, v13
    s_nop 4
    s_cbranch_vccz s1w_done
    s_cmp_lt_u32 s61, 400000
    s_cbranch_scc1 s1w_poll
s1w_done:
    s_mov_b64 exec, -1
s1w_w:
    s_barrier
    s_mov_b32 s48, s4
    s_and_b32 s49, s5, 0xffff
    s_mov_b32 s50, 2097152
    s_mov_b32 s51, 0x20000
    s_mov_b32 s41, 0
    s_cmp_eq_u32 s30, 1
    s_cselect_b32 s41, 98304, s41
    s_cmp_eq_u32 s30, 2
    s_cselect_b32 s41, 116736, s41
    s_cmp_eq_u32 s30, 3
    s_cselect_b32 s41, 135168, s41
    s_mul_i32 s42, s30, 18432
    s_add_u32 s42, s42, 3801088
    s_lshl_b32 s43, s44, 17
    s_lshl_b32 s46, s30, 14
    s_add_u32 s43, s43, s46
    s_add_u32 s43, s43, 4194304
    s_add_u32 m0, s41, 0
    s_add_u32 s46, s42, 0
    buffer_load_dwordx4 v2, s[32:35], s46 offen offset:0 sc1 lds
    buffer_load_dwordx4 v2, s[32:35], s46 offen offset:1024 sc1 lds
    buffer_load_dwordx4 v2, s[32:35], s46 offen offset:2048 sc1 lds
    s_add_u32 s47, s43, 0
    buffer_load_dwordx4 a[0:3], v2, s[32:35], s47 offen sc1
    buffer_load_dwordx4 a[4:7], v2, s[32:35], s47 offen offset:1024 sc1
    s_add_u32 s47, s43, 65536
    buffer_load_dwordx4 a[8:11], v2, s[32:35], s47 offen sc1
    buffer_load_dwordx4 a[12:15], v2, s[32:35], s47 offen offset:1024 sc1
    buffer_load_dwordx4 v2, s[32:35], s46 offen offset:3072 sc1 lds
    s_add_u32 m0, s41, 4096
    s_add_u32 s46, s42, 4096
    buffer_load_dwordx4 v2, s[32:35], s46 offen offset:0 sc1 lds
    s_add_u32 s47, s43, 2048
    buffer_load_dwordx4 a[16:19], v2, s[32:35], s47 offen sc1
    buffer_load_dwordx4 a[20:23], v2, s[32:35], s47 offen offset:1024 sc1
    s_add_u32 s47, s43, 67584
    buffer_load_dwordx4 a[24:27], v2, s[32:35], s47 offen sc1
    buffer_load_dwordx4 a[28:31], v2, s[32:35], s47 offen offset:1024 sc1
    buffer_load_dwordx4 v2, s[32:35], s46 offen offset:1024 sc1 lds
    buffer_load_dwordx4 v2, s[32:35], s46 offen offset:2048 sc1 lds
    s_add_u32 s47, s43, 4096
    buffer_load_dwordx4 a[32:35], v2, s[32:35], s47 offen sc1
    buffer_load_dwordx4 a[36:39], v2, s[32:35], s47 offen offset:1024 sc1
    s_add_u32 s47, s43, 69632
    buffer_load_dwordx4 a[40:43], v2, s[32:35], s47 offen sc1
    v_and_b32 v7, 31, v1
    v_lshrrev_b32 v8, 5, v1
    v_lshlrev_b32 v6, 4, v7
    v_lshl_add_u32 v6, v8, 8, v6
    v_lshlrev_b32 v9, 4, v8
    v_add_u32 v9, 512, v9
    v_cmp_gt_u32 vcc, 16, v7
    s_nop 1
    v_cndmask_b32 v6, v9, v6, vcc
    v_add_u32 v6, s41, v6
    v_mov_b32 v10, 0x358637bd
    v_and_b32 v14, 31, v1
    v_lshlrev_b32 v14, 10, v14
    v_lshrrev_b32 v12, 5, v1
    v_lshl_add_u32 v14, v12, 4, v14
    s_lshl_b32 s55, s30, 5
    v_add_u32 v14, s55, v14
    v_lshlrev_b32 v15, 5, v12
    s_lshl_b32 s55, s30, 6
    v_add_u32 v15, s55, v15
    s_lshl_b32 s52, s44, 16
    s_lshl_b32 s53, s45, 7
    s_add_u32 s52, s52, s53
    s_add_u32 s53, s52, 32768
    s_lshl_b32 s54, s45, 8
    s_add_u32 s54, s54, 3674112
    s_waitcnt vmcnt(11)
    ds_read_b128 v[16:19], v6 offset:0
    ds_read_b128 v[20:23], v6 offset:576
    ds_read_b128 v[24:27], v6 offset:1152
    ds_read_b128 v[28:31], v6 offset:1728
    ds_read_b64_tr_b16 v[128:129], v4 offset:0
    ds_read_b64_tr_b16 v[130:131], v4 offset:1024
    ds_read_b64_tr_b16 v[132:133], v5 offset:0
    ds_read_b64_tr_b16 v[134:135], v5 offset:1024
    s_waitcnt lgkmcnt(4)
    v_cvt_pk_bf16_f32 v48, v16, v17
    v_cvt_pk_bf16_f32 v49, v18, v19
    v_cvt_pk_bf16_f32 v50, v20, v21
    v_cvt_pk_bf16_f32 v51, v22, v23
    v_cvt_pk_bf16_f32 v52, v24, v25
    v_cvt_pk_bf16_f32 v53, v26, v27
    v_cvt_pk_bf16_f32 v54, v28, v29
    v_cvt_pk_bf16_f32 v55, v30, v31
    v_mfma_f32_32x32x16_bf16 v[56:71], v[48:51], a[0:3], 0
    buffer_load_dwordx4 a[44:47], v2, s[32:35], s47 offen offset:1024 sc1
    v_mfma_f32_32x32x16_bf16 v[72:87], v[48:51], a[8:11], 0
    buffer_load_dwordx4 v2, s[32:35], s46 offen offset:3072 sc1 lds
    s_add_u32 m0, s41, 8192
    s_add_u32 s46, s42, 8192
    buffer_load_dwordx4 v2, s[32:35], s46 offen offset:0 sc1 lds
    v_mfma_f32_32x32x16_bf16 v[56:71], v[52:55], a[4:7], v[56:71]
    s_add_u32 s47, s43, 6144
    buffer_load_dwordx4 a[48:51], v2, s[32:35], s47 offen sc1
    v_mfma_f32_32x32x16_bf16 v[72:87], v[52:55], a[12:15], v[72:87]
    buffer_load_dwordx4 a[52:55], v2, s[32:35], s47 offen offset:1024 sc1
    s_add_u32 s47, s43, 71680
    buffer_load_dwordx4 a[56:59], v2, s[32:35], s47 offen sc1
    s_waitcnt vmcnt(11)
    ds_read_b128 v[32:35], v6 offset:2304
    ds_read_b128 v[36:39], v6 offset:2880
    ds_read_b128 v[40:43], v6 offset:3456
    ds_read_b128 v[44:47], v6 offset:4032
    ds_read_b64_tr_b16 v[136:137], v4 offset:2048
    ds_read_b64_tr_b16 v[138:139], v4 offset:3072
    ds_read_b64_tr_b16 v[140:141], v5 offset:2048
    ds_read_b64_tr_b16 v[142:143], v5 offset:3072
    s_waitcnt lgkmcnt(4)
    v_cvt_pk_bf16_f32 v48, v32, v33
    v_cvt_pk_bf16_f32 v49, v34, v35
    v_cvt_pk_bf16_f32 v50, v36, v37
    v_cvt_pk_bf16_f32 v51, v38, v39
    v_cvt_pk_bf16_f32 v52, v40, v41
    v_cvt_pk_bf16_f32 v53, v42, v43
    v_cvt_pk_bf16_f32 v54, v44, v45
    v_cvt_pk_bf16_f32 v55, v46, v47
    v_mfma_f32_32x32x16_bf16 v[88:103], v[48:51], a[16:19], 0
    v_add_f32 v64, v64, v10
    v_rcp_f32 v64, v64
    s_nop 0
    v_mul_f32 v56, v56, v64
    v_mul_f32 v57, v57, v64
    v_mul_f32 v58, v58, v64
    v_mul_f32 v59, v59, v64
    v_mul_f32 v60, v60, v64
    v_mfma_f32_32x32x16_bf16 v[104:119], v[48:51], a[24:27], 0
    v_mul_f32 v61, v61, v64
    v_mul_f32 v62, v62, v64
    v_mul_f32 v63, v63, v64
    v_cvt_pk_bf16_f32 v120, v56, v57
    v_cvt_pk_bf16_f32 v121, v58, v59
    v_cvt_pk_bf16_f32 v122, v60, v61
    v_cvt_pk_bf16_f32 v123, v62, v63
    v_mfma_f32_32x32x16_bf16 v[88:103], v[52:55], a[20:23], v[88:103]
    v_add_f32 v80, v80, v10
    v_rcp_f32 v80, v80
    s_nop 0
    v_mul_f32 v72, v72, v80
    v_mul_f32 v73, v73, v80
    v_mul_f32 v74, v74, v80
    v_mul_f32 v75, v75, v80
    v_mul_f32 v76, v76, v80
    v_mfma_f32_32x32x16_bf16 v[104:119], v[52:55], a[28:31], v[104:119]
    v_mul_f32 v77, v77, v80
    v_mul_f32 v78, v78, v80
    v_mul_f32 v79, v79, v80
    v_cvt_pk_bf16_f32 v124, v72, v73
    v_cvt_pk_bf16_f32 v125, v74, v75
    v_cvt_pk_bf16_f32 v126, v76, v77
    v_cvt_pk_bf16_f32 v127, v78, v79
    v_mfma_f32_32x32x16_bf16 a[128:143], v[128:131], v[120:123], 0
    buffer_load_dwordx4 a[60:63], v2, s[32:35], s47 offen offset:1024 sc1
    buffer_load_dwordx4 v2, s[32:35], s46 offen offset:1024 sc1 lds
    v_mfma_f32_32x32x16_bf16 a[144:159], v[132:135], v[120:123], 0
    buffer_load_dwordx4 v2, s[32:35], s46 offen offset:2048 sc1 lds
    buffer_load_dwordx4 v2, s[32:35], s46 offen offset:3072 sc1 lds
    v_mfma_f32_32x32x16_bf16 a[160:175], v[128:131], v[124:127], 0
    s_add_u32 s47, s43, 8192
    buffer_load_dwordx4 a[64:67], v2, s[32:35], s47 offen sc1
    buffer_load_dwordx4 a[68:71], v2, s[32:35], s47 offen offset:1024 sc1
    v_mfma_f32_32x32x16_bf16 a[176:191], v[132:135], v[124:127], 0
    s_add_u32 s47, s43, 73728
    buffer_load_dwordx4 a[72:75], v2, s[32:35], s47 offen sc1
    buffer_load_dwordx4 a[76:79], v2, s[32:35], s47 offen offset:1024 sc1
    s_waitcnt vmcnt(13)
    ds_read_b128 v[16:19], v6 offset:4608
    ds_read_b128 v[20:23], v6 offset:5184
    ds_read_b128 v[24:27], v6 offset:5760
    ds_read_b128 v[28:31], v6 offset:6336
    ds_read_b64_tr_b16 v[128:129], v4 offset:4096
    ds_read_b64_tr_b16 v[130:131], v4 offset:5120
    ds_read_b64_tr_b16 v[132:133], v5 offset:4096
    ds_read_b64_tr_b16 v[134:135], v5 offset:5120
    s_waitcnt lgkmcnt(4)
    v_cvt_pk_bf16_f32 v48, v16, v17
    v_cvt_pk_bf16_f32 v49, v18, v19
    v_cvt_pk_bf16_f32 v50, v20, v21
    v_cvt_pk_bf16_f32 v51, v22, v23
    v_cvt_pk_bf16_f32 v52, v24, v25
    v_cvt_pk_bf16_f32 v53, v26, v27
    v_cvt_pk_bf16_f32 v54, v28, v29
    v_cvt_pk_bf16_f32 v55, v30, v31
    v_mfma_f32_32x32x16_bf16 v[56:71], v[48:51], a[32:35], 0
    v_add_f32 v96, v96, v10
    v_rcp_f32 v96, v96
    s_nop 0
    v_mul_f32 v88, v88, v96
    v_mul_f32 v89, v89, v96
    v_mul_f32 v90, v90, v96
    v_mul_f32 v91, v91, v96
    v_mul_f32 v92, v92, v96
    v_mfma_f32_32x32x16_bf16 v[72:87], v[48:51], a[40:43], 0
    v_mul_f32 v93, v93, v96
    v_mul_f32 v94, v94, v96
    v_mul_f32 v95, v95, v96
    v_cvt_pk_bf16_f32 v120, v88, v89
    v_cvt_pk_bf16_f32 v121, v90, v91
    v_cvt_pk_bf16_f32 v122, v92, v93
    v_cvt_pk_bf16_f32 v123, v94, v95
    v_mfma_f32_32x32x16_bf16 v[56:71], v[52:55], a[36:39], v[56:71]
    v_add_f32 v112, v112, v10
    v_rcp_f32 v112, v112
    s_nop 0
    v_mul_f32 v104, v104, v112
    v_mul_f32 v105, v105, v112
    v_mul_f32 v106, v106, v112
    v_mul_f32 v107, v107, v112
    v_mul_f32 v108, v108, v112
    v_mfma_f32_32x32x16_bf16 v[72:87], v[52:55], a[44:47], v[72:87]
    v_mul_f32 v109, v109, v112
    v_mul_f32 v110, v110, v112
    v_mul_f32 v111, v111, v112
    v_cvt_pk_bf16_f32 v124, v104, v105
    v_cvt_pk_bf16_f32 v125, v106, v107
    v_cvt_pk_bf16_f32 v126, v108, v109
    v_cvt_pk_bf16_f32 v127, v110, v111
    v_mfma_f32_32x32x16_bf16 a[128:143], v[136:139], v[120:123], a[128:143]
    s_add_u32 m0, s41, 12288
    s_add_u32 s46, s42, 12288
    buffer_load_dwordx4 v2, s[32:35], s46 offen offset:0 sc1 lds
    buffer_load_dwordx4 v2, s[32:35], s46 offen offset:1024 sc1 lds
    v_mfma_f32_32x32x16_bf16 a[144:159], v[140:143], v[120:123], a[144:159]
    s_add_u32 s47, s43, 10240
    buffer_load_dwordx4 a[80:83], v2, s[32:35], s47 offen sc1
    buffer_load_dwordx4 a[84:87], v2, s[32:35], s47 offen offset:1024 sc1
    v_mfma_f32_32x32x16_bf16 a[160:175], v[136:139], v[124:127], a[160:175]
    s_add_u32 s47, s43, 75776
    buffer_load_dwordx4 a[88:91], v2, s[32:35], s47 offen sc1
    buffer_load_dwordx4 a[92:95], v2, s[32:35], s47 offen offset:1024 sc1
    v_mfma_f32_32x32x16_bf16 a[176:191], v[140:143], v[124:127], a[176:191]
    buffer_load_dwordx4 v2, s[32:35], s46 offen offset:2048 sc1 lds
    buffer_load_dwordx4 v2, s[32:35], s46 offen offset:3072 sc1 lds
    s_waitcnt vmcnt(15)
    ds_read_b128 v[32:35], v6 offset:6912
    ds_read_b128 v[36:39], v6 offset:7488
    ds_read_b128 v[40:43], v6 offset:8064
    ds_read_b128 v[44:47], v6 offset:8640
    ds_read_b64_tr_b16 v[136:137], v4 offset:6144
    ds_read_b64_tr_b16 v[138:139], v4 offset:7168
    ds_read_b64_tr_b16 v[140:141], v5 offset:6144
    ds_read_b64_tr_b16 v[142:143], v5 offset:7168
    s_waitcnt lgkmcnt(4)
    v_cvt_pk_bf16_f32 v48, v32, v33
    v_cvt_pk_bf16_f32 v49, v34, v35
    v_cvt_pk_bf16_f32 v50, v36, v37
    v_cvt_pk_bf16_f32 v51, v38, v39
    v_cvt_pk_bf16_f32 v52, v40, v41
    v_cvt_pk_bf16_f32 v53, v42, v43
    v_cvt_pk_bf16_f32 v54, v44, v45
    v_cvt_pk_bf16_f32 v55, v46, v47
    v_mfma_f32_32x32x16_bf16 v[88:103], v[48:51], a[48:51], 0
    v_add_f32 v64, v64, v10
    v_rcp_f32 v64, v64
    s_nop 0
    v_mul_f32 v56, v56, v64
    v_mul_f32 v57, v57, v64
    v_mul_f32 v58, v58, v64
    v_mul_f32 v59, v59, v64
    v_mul_f32 v60, v60, v64
    v_mfma_f32_32x32x16_bf16 v[104:119], v[48:51], a[56:59], 0
    v_mul_f32 v61, v61, v64
    v_mul_f32 v62, v62, v64
    v_mul_f32 v63, v63, v64
    v_cvt_pk_bf16_f32 v120, v56, v57
    v_cvt_pk_bf16_f32 v121, v58, v59
    v_cvt_pk_bf16_f32 v122, v60, v61
    v_cvt_pk_bf16_f32 v123, v62, v63
    v_mfma_f32_32x32x16_bf16 v[88:103], v[52:55], a[52:55], v[88:103]
    v_add_f32 v80, v80, v10
    v_rcp_f32 v80, v80
    s_nop 0
    v_mul_f32 v72, v72, v80
    v_mul_f32 v73, v73, v80
    v_mul_f32 v74, v74, v80
    v_mul_f32 v75, v75, v80
    v_mul_f32 v76, v76, v80
    v_mfma_f32_32x32x16_bf16 v[104:119], v[52:55], a[60:63], v[104:119]
    v_mul_f32 v77, v77, v80
    v_mul_f32 v78, v78, v80
    v_mul_f32 v79, v79, v80
    v_cvt_pk_bf16_f32 v124, v72, v73
    v_cvt_pk_bf16_f32 v125, v74, v75
    v_cvt_pk_bf16_f32 v126, v76, v77
    v_cvt_pk_bf16_f32 v127, v78, v79
    v_mfma_f32_32x32x16_bf16 a[128:143], v[128:131], v[120:123], a[128:143]
    s_add_u32 s47, s43, 12288
    buffer_load_dwordx4 a[96:99], v2, s[32:35], s47 offen sc1
    buffer_load_dwordx4 a[100:103], v2, s[32:35], s47 offen offset:1024 sc1
    v_mfma_f32_32x32x16_bf16 a[144:159], v[132:135], v[120:123], a[144:159]
    s_add_u32 s47, s43, 77824
    buffer_load_dwordx4 a[104:107], v2, s[32:35], s47 offen sc1
    buffer_load_dwordx4 a[108:111], v2, s[32:35], s47 offen offset:1024 sc1
    v_mfma_f32_32x32x16_bf16 a[160:175], v[128:131], v[124:127], a[160:175]
    s_add_u32 m0, s41, 16384
    s_add_u32 s46, s42, 16384
    buffer_load_dwordx4 v2, s[32:35], s46 offen offset:0 sc1 lds
    buffer_load_dwordx4 v2, s[32:35], s46 offen offset:1024 sc1 lds
    v_mfma_f32_32x32x16_bf16 a[176:191], v[132:135], v[124:127], a[176:191]
    s_add_u32 s47, s43, 14336
    buffer_load_dwordx4 a[112:115], v2, s[32:35], s47 offen sc1
    buffer_load_dwordx4 a[116:119], v2, s[32:35], s47 offen offset:1024 sc1
    s_waitcnt vmcnt(16)
    ds_read_b128 v[16:19], v6 offset:9216
    ds_read_b128 v[20:23], v6 offset:9792
    ds_read_b128 v[24:27], v6 offset:10368
    ds_read_b128 v[28:31], v6 offset:10944
    ds_read_b64_tr_b16 v[128:129], v4 offset:8192
    ds_read_b64_tr_b16 v[130:131], v4 offset:9216
    ds_read_b64_tr_b16 v[132:133], v5 offset:8192
    ds_read_b64_tr_b16 v[134:135], v5 offset:9216
    s_waitcnt lgkmcnt(4)
    v_cvt_pk_bf16_f32 v48, v16, v17
    v_cvt_pk_bf16_f32 v49, v18, v19
    v_cvt_pk_bf16_f32 v50, v20, v21
    v_cvt_pk_bf16_f32 v51, v22, v23
    v_cvt_pk_bf16_f32 v52, v24, v25
    v_cvt_pk_bf16_f32 v53, v26, v27
    v_cvt_pk_bf16_f32 v54, v28, v29
    v_cvt_pk_bf16_f32 v55, v30, v31
    v_mfma_f32_32x32x16_bf16 v[56:71], v[48:51], a[64:67], 0
    v_add_f32 v96, v96, v10
    v_rcp_f32 v96, v96
    s_nop 0
    v_mul_f32 v88, v88, v96
    v_mul_f32 v89, v89, v96
    v_mul_f32 v90, v90, v96
    v_mul_f32 v91, v91, v96
    v_mul_f32 v92, v92, v96
    v_mfma_f32_32x32x16_bf16 v[72:87], v[48:51], a[72:75], 0
    v_mul_f32 v93, v93, v96
    v_mul_f32 v94, v94, v96
    v_mul_f32 v95, v95, v96
    v_cvt_pk_bf16_f32 v120, v88, v89
    v_cvt_pk_bf16_f32 v121, v90, v91
    v_cvt_pk_bf16_f32 v122, v92, v93
    v_cvt_pk_bf16_f32 v123, v94, v95
    v_mfma_f32_32x32x16_bf16 v[56:71], v[52:55], a[68:71], v[56:71]
    v_add_f32 v112, v112, v10
    v_rcp_f32 v112, v112
    s_nop 0
    v_mul_f32 v104, v104, v112
    v_mul_f32 v105, v105, v112
    v_mul_f32 v106, v106, v112
    v_mul_f32 v107, v107, v112
    v_mul_f32 v108, v108, v112
    v_mfma_f32_32x32x16_bf16 v[72:87], v[52:55], a[76:79], v[72:87]
    v_mul_f32 v109, v109, v112
    v_mul_f32 v110, v110, v112
    v_mul_f32 v111, v111, v112
    v_cvt_pk_bf16_f32 v124, v104, v105
    v_cvt_pk_bf16_f32 v125, v106, v107
    v_cvt_pk_bf16_f32 v126, v108, v109
    v_cvt_pk_bf16_f32 v127, v110, v111
    v_mfma_f32_32x32x16_bf16 a[128:143], v[136:139], v[120:123], a[128:143]
    s_add_u32 s47, s43, 79872
    buffer_load_dwordx4 a[120:123], v2, s[32:35], s47 offen sc1
    buffer_load_dwordx4 a[124:127], v2, s[32:35], s47 offen offset:1024 sc1
    v_mfma_f32_32x32x16_bf16 a[144:159], v[140:143], v[120:123], a[144:159]
    buffer_store_dwordx4 v[228:231], v2, s[32:35], s97 offen sc1
    s_add_u32 s97, s97, 7168
    buffer_store_dwordx4 v[232:235], v2, s[32:35], s97 offen sc1
    v_mfma_f32_32x32x16_bf16 a[160:175], v[136:139], v[124:127], a[160:175]
    s_add_u32 s97, s97, 7168
    buffer_store_dwordx4 v[236:239], v2, s[32:35], s97 offen sc1
    s_add_u32 s97, s97, 7168
    buffer_store_dwordx4 v[240:243], v2, s[32:35], s97 offen sc1
    v_mfma_f32_32x32x16_bf16 a[176:191], v[140:143], v[124:127], a[176:191]
    buffer_atomic_add_f32 v246, v221, s[32:35], s96 offen
    buffer_load_dwordx4 v[144:147], v14, s[48:51], s52 offen
    s_waitcnt vmcnt(18)
    ds_read_b128 v[32:35], v6 offset:11520
    ds_read_b128 v[36:39], v6 offset:12096
    ds_read_b128 v[40:43], v6 offset:12672
    ds_read_b128 v[44:47], v6 offset:13248
    ds_read_b64_tr_b16 v[136:137], v4 offset:10240
    ds_read_b64_tr_b16 v[138:139], v4 offset:11264
    ds_read_b64_tr_b16 v[140:141], v5 offset:10240
    ds_read_b64_tr_b16 v[142:143], v5 offset:11264
    s_waitcnt lgkmcnt(4)
    v_cvt_pk_bf16_f32 v48, v32, v33
    v_cvt_pk_bf16_f32 v49, v34, v35
    v_cvt_pk_bf16_f32 v50, v36, v37
    v_cvt_pk_bf16_f32 v51, v38, v39
    v_cvt_pk_bf16_f32 v52, v40, v41
    v_cvt_pk_bf16_f32 v53, v42, v43
    v_cvt_pk_bf16_f32 v54, v44, v45
    v_cvt_pk_bf16_f32 v55, v46, v47
    v_mfma_f32_32x32x16_bf16 v[88:103], v[48:51], a[80:83], 0
    v_add_f32 v64, v64, v10
    v_rcp_f32 v64, v64
    s_nop 0
    v_mul_f32 v56, v56, v64
    v_mul_f32 v57, v57, v64
    v_mul_f32 v58, v58, v64
    v_mul_f32 v59, v59, v64
    v_mul_f32 v60, v60, v64
    v_mfma_f32_32x32x16_bf16 v[104:119], v[48:51], a[88:91], 0
    v_mul_f32 v61, v61, v64
    v_mul_f32 v62, v62, v64
    v_mul_f32 v63, v63, v64
    v_cvt_pk_bf16_f32 v120, v56, v57
    v_cvt_pk_bf16_f32 v121, v58, v59
    v_cvt_pk_bf16_f32 v122, v60, v61
    v_cvt_pk_bf16_f32 v123, v62, v63
    v_mfma_f32_32x32x16_bf16 v[88:103], v[52:55], a[84:87], v[88:103]
    v_add_f32 v80, v80, v10
    v_rcp_f32 v80, v80
    s_nop 0
    v_mul_f32 v72, v72, v80
    v_mul_f32 v73, v73, v80
    v_mul_f32 v74, v74, v80
    v_mul_f32 v75, v75, v80
    v_mul_f32 v76, v76, v80
    v_mfma_f32_32x32x16_bf16 v[104:119], v[52:55], a[92:95], v[104:119]
    v_mul_f32 v77, v77, v80
    v_mul_f32 v78, v78, v80
    v_mul_f32 v79, v79, v80
    v_cvt_pk_bf16_f32 v124, v72, v73
    v_cvt_pk_bf16_f32 v125, v74, v75
    v_cvt_pk_bf16_f32 v126, v76, v77
    v_cvt_pk_bf16_f32 v127, v78, v79
    v_mfma_f32_32x32x16_bf16 a[128:143], v[128:131], v[120:123], a[128:143]
    v_mfma_f32_32x32x16_bf16 a[144:159], v[132:135], v[120:123], a[144:159]
    buffer_load_dwordx4 v[148:151], v14, s[48:51], s53 offen
    v_mfma_f32_32x32x16_bf16 a[160:175], v[128:131], v[124:127], a[160:175]
    buffer_load_dwordx4 v[152:155], v15, s[32:35], s54 offen sc1
    v_mfma_f32_32x32x16_bf16 a[176:191], v[132:135], v[124:127], a[176:191]
    buffer_load_dwordx4 v[156:159], v15, s[32:35], s54 offen offset:16 sc1
    s_waitcnt vmcnt(15)
    ds_read_b128 v[16:19], v6 offset:13824
    ds_read_b128 v[20:23], v6 offset:14400
    ds_read_b128 v[24:27], v6 offset:14976
    ds_read_b128 v[28:31], v6 offset:15552
    ds_read_b64_tr_b16 v[128:129], v4 offset:12288
    ds_read_b64_tr_b16 v[130:131], v4 offset:13312
    ds_read_b64_tr_b16 v[132:133], v5 offset:12288
    ds_read_b64_tr_b16 v[134:135], v5 offset:13312
    s_waitcnt lgkmcnt(4)
    v_cvt_pk_bf16_f32 v48, v16, v17
    v_cvt_pk_bf16_f32 v49, v18, v19
    v_cvt_pk_bf16_f32 v50, v20, v21
    v_cvt_pk_bf16_f32 v51, v22, v23
    v_cvt_pk_bf16_f32 v52, v24, v25
    v_cvt_pk_bf16_f32 v53, v26, v27
    v_cvt_pk_bf16_f32 v54, v28, v29
    v_cvt_pk_bf16_f32 v55, v30, v31
    v_mfma_f32_32x32x16_bf16 v[56:71], v[48:51], a[96:99], 0
    v_add_f32 v96, v96, v10
    v_rcp_f32 v96, v96
    s_nop 0
    v_mul_f32 v88, v88, v96
    v_mul_f32 v89, v89, v96
    v_mul_f32 v90, v90, v96
    v_mul_f32 v91, v91, v96
    v_mul_f32 v92, v92, v96
    v_mfma_f32_32x32x16_bf16 v[72:87], v[48:51], a[104:107], 0
    v_mul_f32 v93, v93, v96
    v_mul_f32 v94, v94, v96
    v_mul_f32 v95, v95, v96
    v_cvt_pk_bf16_f32 v120, v88, v89
    v_cvt_pk_bf16_f32 v121, v90, v91
    v_cvt_pk_bf16_f32 v122, v92, v93
    v_cvt_pk_bf16_f32 v123, v94, v95
    v_mfma_f32_32x32x16_bf16 v[56:71], v[52:55], a[100:103], v[56:71]
    v_add_f32 v112, v112, v10
    v_rcp_f32 v112, v112
    s_nop 0
    v_mul_f32 v104, v104, v112
    v_mul_f32 v105, v105, v112
    v_mul_f32 v106, v106, v112
    v_mul_f32 v107, v107, v112
    v_mul_f32 v108, v108, v112
    v_mfma_f32_32x32x16_bf16 v[72:87], v[52:55], a[108:111], v[72:87]
    v_mul_f32 v109, v109, v112
    v_mul_f32 v110, v110, v112
    v_mul_f32 v111, v111, v112
    v_cvt_pk_bf16_f32 v124, v104, v105
    v_cvt_pk_bf16_f32 v125, v106, v107
    v_cvt_pk_bf16_f32 v126, v108, v109
    v_cvt_pk_bf16_f32 v127, v110, v111
    v_mfma_f32_32x32x16_bf16 a[128:143], v[136:139], v[120:123], a[128:143]
    v_mfma_f32_32x32x16_bf16 a[144:159], v[140:143], v[120:123], a[144:159]
    v_mfma_f32_32x32x16_bf16 a[160:175], v[136:139], v[124:127], a[160:175]
    v_mfma_f32_32x32x16_bf16 a[176:191], v[140:143], v[124:127], a[176:191]
    s_waitcnt vmcnt(9)
    ds_read_b128 v[32:35], v6 offset:16128
    ds_read_b128 v[36:39], v6 offset:16704
    ds_read_b128 v[40:43], v6 offset:17280
    ds_read_b128 v[44:47], v6 offset:17856
    ds_read_b64_tr_b16 v[136:137], v4 offset:14336
    ds_read_b64_tr_b16 v[138:139], v4 offset:15360
    ds_read_b64_tr_b16 v[140:141], v5 offset:14336
    ds_read_b64_tr_b16 v[142:143], v5 offset:15360
    s_waitcnt lgkmcnt(4)
    v_cvt_pk_bf16_f32 v48, v32, v33
    v_cvt_pk_bf16_f32 v49, v34, v35
    v_cvt_pk_bf16_f32 v50, v36, v37
    v_cvt_pk_bf16_f32 v51, v38, v39
    v_cvt_pk_bf16_f32 v52, v40, v41
    v_cvt_pk_bf16_f32 v53, v42, v43
    v_cvt_pk_bf16_f32 v54, v44, v45
    v_cvt_pk_bf16_f32 v55, v46, v47
    v_mfma_f32_32x32x16_bf16 v[88:103], v[48:51], a[112:115], 0
    v_add_f32 v64, v64, v10
    v_rcp_f32 v64, v64
    s_nop 0
    v_mul_f32 v56, v56, v64
    v_mul_f32 v57, v57, v64
    v_mul_f32 v58, v58, v64
    v_mul_f32 v59, v59, v64
    v_mul_f32 v60, v60, v64
    v_mfma_f32_32x32x16_bf16 v[104:119], v[48:51], a[120:123], 0
    v_mul_f32 v61, v61, v64
    v_mul_f32 v62, v62, v64
    v_mul_f32 v63, v63, v64
    v_cvt_pk_bf16_f32 v120, v56, v57
    v_cvt_pk_bf16_f32 v121, v58, v59
    v_cvt_pk_bf16_f32 v122, v60, v61
    v_cvt_pk_bf16_f32 v123, v62, v63
    v_mfma_f32_32x32x16_bf16 v[88:103], v[52:55], a[116:119], v[88:103]
    v_add_f32 v80, v80, v10
    v_rcp_f32 v80, v80
    s_nop 0
    v_mul_f32 v72, v72, v80
    v_mul_f32 v73, v73, v80
    v_mul_f32 v74, v74, v80
    v_mul_f32 v75, v75, v80
    v_mul_f32 v76, v76, v80
    v_mfma_f32_32x32x16_bf16 v[104:119], v[52:55], a[124:127], v[104:119]
    v_mul_f32 v77, v77, v80
    v_mul_f32 v78, v78, v80
    v_mul_f32 v79, v79, v80
    v_cvt_pk_bf16_f32 v124, v72, v73
    v_cvt_pk_bf16_f32 v125, v74, v75
    v_cvt_pk_bf16_f32 v126, v76, v77
    v_cvt_pk_bf16_f32 v127, v78, v79
    v_mfma_f32_32x32x16_bf16 a[128:143], v[128:131], v[120:123], a[128:143]
    v_mfma_f32_32x32x16_bf16 a[144:159], v[132:135], v[120:123], a[144:159]
    v_mfma_f32_32x32x16_bf16 a[160:175], v[128:131], v[124:127], a[160:175]
    v_mfma_f32_32x32x16_bf16 a[176:191], v[132:135], v[124:127], a[176:191]
    v_add_f32 v96, v96, v10
    v_rcp_f32 v96, v96
    s_nop 0
    v_mul_f32 v88, v88, v96
    v_mul_f32 v89, v89, v96
    v_mul_f32 v90, v90, v96
    v_mul_f32 v91, v91, v96
    v_mul_f32 v92, v92, v96
    v_mul_f32 v93, v93, v96
    v_mul_f32 v94, v94, v96
    v_mul_f32 v95, v95, v96
    v_cvt_pk_bf16_f32 v120, v88, v89
    v_cvt_pk_bf16_f32 v121, v90, v91
    v_cvt_pk_bf16_f32 v122, v92, v93
    v_cvt_pk_bf16_f32 v123, v94, v95
    v_add_f32 v112, v112, v10
    v_rcp_f32 v112, v112
    s_nop 0
    v_mul_f32 v104, v104, v112
    v_mul_f32 v105, v105, v112
    v_mul_f32 v106, v106, v112
    v_mul_f32 v107, v107, v112
    v_mul_f32 v108, v108, v112
    v_mul_f32 v109, v109, v112
    v_mul_f32 v110, v110, v112
    v_mul_f32 v111, v111, v112
    v_cvt_pk_bf16_f32 v124, v104, v105
    v_cvt_pk_bf16_f32 v125, v106, v107
    v_cvt_pk_bf16_f32 v126, v108, v109
    v_cvt_pk_bf16_f32 v127, v110, v111
    s_waitcnt lgkmcnt(0)
    v_mfma_f32_32x32x16_bf16 a[128:143], v[136:139], v[120:123], a[128:143]
    v_mfma_f32_32x32x16_bf16 a[144:159], v[140:143], v[120:123], a[144:159]
    v_mfma_f32_32x32x16_bf16 a[160:175], v[136:139], v[124:127], a[160:175]
    v_mfma_f32_32x32x16_bf16 a[176:191], v[140:143], v[124:127], a[176:191]
    s_waitcnt vmcnt(0)
    s_barrier
    v_and_b32 v18, 31, v1
    v_mul_u32_u24 v18, 272, v18
    v_lshrrev_b32 v19, 5, v1
    v_lshl_add_u32 v18, v19, 4, v18
    s_mul_i32 s40, s30, 17408
    v_add_u32 v18, s40, v18
    s_nop 0
    ds_write_b128 v18, a[128:131] offset:0
    ds_write_b128 v18, a[132:135] offset:32
    ds_write_b128 v18, a[136:139] offset:64
    ds_write_b128 v18, a[140:143] offset:96
    ds_write_b128 v18, a[144:147] offset:128
    ds_write_b128 v18, a[148:151] offset:160
    ds_write_b128 v18, a[152:155] offset:192
    ds_write_b128 v18, a[156:159] offset:224
    ds_write_b128 v18, a[160:163] offset:8704
    ds_write_b128 v18, a[164:167] offset:8736
    ds_write_b128 v18, a[168:171] offset:8768
    ds_write_b128 v18, a[172:175] offset:8800
    ds_write_b128 v18, a[176:179] offset:8832
    ds_write_b128 v18, a[180:183] offset:8864
    ds_write_b128 v18, a[184:187] offset:8896
    ds_write_b128 v18, a[188:191] offset:8928
    s_cmp_ge_u32 s2, 224
    s_cbranch_scc1 ska_skip
    s_lshl_b32 s58, s63, 2
    s_add_u32 s59, s58, 3
    s_mul_i32 s58, s58, 9363
    s_lshr_b32 s58, s58, 16
    s_mul_i32 s59, s59, 9363
    s_lshr_b32 s59, s59, 16
    s_cmp_lg_u32 s30, 0
    s_cbranch_scc1 ska0_skip
    s_lshl_b32 s60, s58, 8
    s_add_u32 s60, s60, 3985408
    v_mov_b32 v20, 0
    v_mov_b32 v21, 1
    s_mov_b64 exec, 1
    buffer_atomic_add v21, v20, s[32:35], s60 offen
    s_mov_b64 exec, -1
ska0_skip:
    s_cmp_eq_u32 s58, s59
    s_cbranch_scc1 ska_skip
    s_cmp_lg_u32 s30, 0
    s_cbranch_scc1 ska1_skip
    s_lshl_b32 s60, s59, 8
    s_add_u32 s60, s60, 3985408
    v_mov_b32 v20, 0
    v_mov_b32 v21, 1
    s_mov_b64 exec, 1
    buffer_atomic_add v21, v20, s[32:35], s60 offen
    s_mov_b64 exec, -1
ska1_skip:
ska_skip:
    s_lshl_b32 s46, s44, 16
    s_lshl_b32 s47, s45, 12
    s_add_u32 s46, s46, s47
    s_lshl_b32 s47, s30, 10
    s_add_u32 s46, s46, s47
    s_add_u32 s46, s46, 8388608
    s_add_u32 s54, s46, 32768
    s_lshl_b32 s47, s45, 14
    s_lshl_b32 s55, s44, 9
    s_add_u32 s47, s47, s55
    s_add_u32 s47, s47, 12582912
    s_waitcnt lgkmcnt(0)
    s_barrier
    v_and_b32 v18, 31, v1
    v_mul_u32_u24 v18, 272, v18
    v_lshrrev_b32 v19, 5, v1
    v_lshl_add_u32 v18, v19, 5, v18
    s_lshl_b32 s55, s30, 6
    v_add_u32 v18, s55, v18
    ds_read_b128 v[56:59], v18 offset:0
    ds_read_b128 v[60:63], v18 offset:16
    ds_read_b128 v[64:67], v18 offset:8704
    ds_read_b128 v[68:71], v18 offset:8720
    ds_read_b128 v[72:75], v18 offset:17408
    ds_read_b128 v[76:79], v18 offset:17424
    ds_read_b128 v[80:83], v18 offset:26112
    ds_read_b128 v[84:87], v18 offset:26128
    ds_read_b128 v[88:91], v18 offset:34816
    ds_read_b128 v[92:95], v18 offset:34832
    ds_read_b128 v[96:99], v18 offset:43520
    ds_read_b128 v[100:103], v18 offset:43536
    ds_read_b128 v[104:107], v18 offset:52224
    ds_read_b128 v[108:111], v18 offset:52240
    ds_read_b128 v[112:115], v18 offset:60928
    ds_read_b128 v[116:119], v18 offset:60944
    s_waitcnt lgkmcnt(8)
    v_pk_add_f32 v[56:57], v[56:57], v[72:73]
    v_pk_add_f32 v[58:59], v[58:59], v[74:75]
    v_pk_add_f32 v[60:61], v[60:61], v[76:77]
    v_pk_add_f32 v[62:63], v[62:63], v[78:79]
    v_pk_add_f32 v[64:65], v[64:65], v[80:81]
    v_pk_add_f32 v[66:67], v[66:67], v[82:83]
    v_pk_add_f32 v[68:69], v[68:69], v[84:85]
    v_pk_add_f32 v[70:71], v[70:71], v[86:87]
    s_waitcnt lgkmcnt(0)
    v_pk_add_f32 v[88:89], v[88:89], v[104:105]
    v_pk_add_f32 v[90:91], v[90:91], v[106:107]
    v_pk_add_f32 v[92:93], v[92:93], v[108:109]
    v_pk_add_f32 v[94:95], v[94:95], v[110:111]
    v_pk_add_f32 v[96:97], v[96:97], v[112:113]
    v_pk_add_f32 v[98:99], v[98:99], v[114:115]
    v_pk_add_f32 v[100:101], v[100:101], v[116:117]
    v_pk_add_f32 v[102:103], v[102:103], v[118:119]
    v_pk_add_f32 v[56:57], v[56:57], v[88:89]
    v_pk_add_f32 v[58:59], v[58:59], v[90:91]
    v_pk_add_f32 v[60:61], v[60:61], v[92:93]
    v_pk_add_f32 v[62:63], v[62:63], v[94:95]
    v_pk_add_f32 v[64:65], v[64:65], v[96:97]
    v_pk_add_f32 v[66:67], v[66:67], v[98:99]
    v_pk_add_f32 v[68:69], v[68:69], v[100:101]
    v_pk_add_f32 v[70:71], v[70:71], v[102:103]
    v_lshlrev_b32 v24, 16, v144
    v_and_b32 v25, 0xffff0000, v144
    v_lshlrev_b32 v26, 16, v145
    v_and_b32 v27, 0xffff0000, v145
    v_lshlrev_b32 v28, 16, v146
    v_and_b32 v29, 0xffff0000, v146
    v_lshlrev_b32 v30, 16, v147
    v_and_b32 v31, 0xffff0000, v147
    v_pk_fma_f32 v[24:25], v[152:153], v[56:57], v[24:25]
    v_pk_fma_f32 v[26:27], v[154:155], v[58:59], v[26:27]
    v_pk_fma_f32 v[28:29], v[156:157], v[60:61], v[28:29]
    v_pk_fma_f32 v[30:31], v[158:159], v[62:63], v[30:31]
    v_cvt_pk_bf16_f32 v40, v24, v25
    v_cvt_pk_bf16_f32 v41, v26, v27
    v_cvt_pk_bf16_f32 v42, v28, v29
    v_cvt_pk_bf16_f32 v43, v30, v31
    buffer_store_dwordx4 v[40:43], v2, s[32:35], s46 offen sc1
    v_pk_add_f32 v[48:49], v[24:25], v[26:27]
    v_pk_mul_f32 v[50:51], v[24:25], v[24:25]
    v_pk_add_f32 v[48:49], v[48:49], v[28:29]
    v_pk_add_f32 v[48:49], v[48:49], v[30:31]
    v_pk_fma_f32 v[50:51], v[26:27], v[26:27], v[50:51]
    v_pk_fma_f32 v[50:51], v[28:29], v[28:29], v[50:51]
    v_pk_fma_f32 v[50:51], v[30:31], v[30:31], v[50:51]
    v_add_f32 v48, v48, v49
    v_add_f32 v49, v50, v51
    v_lshlrev_b32 v32, 16, v148
    v_and_b32 v33, 0xffff0000, v148
    v_lshlrev_b32 v34, 16, v149
    v_and_b32 v35, 0xffff0000, v149
    v_lshlrev_b32 v36, 16, v150
    v_and_b32 v37, 0xffff0000, v150
    v_lshlrev_b32 v38, 16, v151
    v_and_b32 v39, 0xffff0000, v151
    v_pk_fma_f32 v[32:33], v[152:153], v[64:65], v[32:33]
    v_pk_fma_f32 v[34:35], v[154:155], v[66:67], v[34:35]
    v_pk_fma_f32 v[36:37], v[156:157], v[68:69], v[36:37]
    v_pk_fma_f32 v[38:39], v[158:159], v[70:71], v[38:39]
    v_cvt_pk_bf16_f32 v44, v32, v33
    v_cvt_pk_bf16_f32 v45, v34, v35
    v_cvt_pk_bf16_f32 v46, v36, v37
    v_cvt_pk_bf16_f32 v47, v38, v39
    buffer_store_dwordx4 v[44:47], v2, s[32:35], s54 offen sc1
    v_pk_add_f32 v[52:53], v[32:33], v[34:35]
    v_pk_mul_f32 v[54:55], v[32:33], v[32:33]
    v_pk_add_f32 v[52:53], v[52:53], v[36:37]
    v_pk_add_f32 v[52:53], v[52:53], v[38:39]
    v_pk_fma_f32 v[54:55], v[34:35], v[34:35], v[54:55]
    v_pk_fma_f32 v[54:55], v[36:37], v[36:37], v[54:55]
    v_pk_fma_f32 v[54:55], v[38:39], v[38:39], v[54:55]
    v_add_f32 v52, v52, v53
    v_add_f32 v53, v54, v55
    s_nop 0
    v_permlane32_swap_b32 v48, v52
    v_permlane32_swap_b32 v49, v53
    v_pk_add_f32 v[48:49], v[48:49], v[52:53]
    v_lshlrev_b32 v16, 3, v1
    s_lshl_b32 s55, s30, 9
    s_add_u32 s55, s55, 69632
    v_add_u32 v17, s55, v16
    ds_write_b64 v17, v[48:49]
    s_waitcnt lgkmcnt(0)
    s_barrier
    s_cmp_lg_u32 s30, 0
    s_cbranch_scc1 p23_nostat
    v_add_u32 v17, 69632, v16
    ds_read_b64 v[48:49], v17 offset:0
    ds_read_b64 v[50:51], v17 offset:512
    ds_read_b64 v[52:53], v17 offset:1024
    ds_read_b64 v[54:55], v17 offset:1536
    s_waitcnt lgkmcnt(0)
    v_pk_add_f32 v[48:49], v[48:49], v[50:51]
    v_pk_add_f32 v[52:53], v[52:53], v[54:55]
    v_pk_add_f32 v[48:49], v[48:49], v[52:53]
    buffer_store_dwordx2 v[48:49], v16, s[32:35], s47 offen sc1
p23_nostat:
    v_accvgpr_write_b32 a248, v40
    v_accvgpr_write_b32 a249, v41
    v_accvgpr_write_b32 a250, v42
    v_accvgpr_write_b32 a251, v43
    v_accvgpr_write_b32 a252, v44
    v_accvgpr_write_b32 a253, v45
    v_accvgpr_write_b32 a254, v46
    v_accvgpr_write_b32 a255, v47
    s_lshr_b32 s63, s44, 1
    s_and_b32 s40, s2, 7
    s_lshr_b32 s41, s2, 3
    s_lshr_b32 s44, s40, 2
    s_lshl_b32 s44, s44, 3
    s_lshr_b32 s45, s41, 2
    s_add_u32 s44, s44, s45
    s_and_b32 s40, s40, 3
    s_lshl_b32 s40, s40, 2
    s_and_b32 s41, s41, 3
    s_add_u32 s45, s40, s41
    s_lshl_b32 s46, s44, 2
    s_add_u32 s46, s46, s30
    s_mul_i32 s40, s45, 229376
    s_mul_i32 s41, s30, 7168
    s_add_u32 s40, s40, s41
    s_add_u32 s40, s40, 13631488
    s_lshl_b32 s41, s30, 12
    s_mul_i32 s42, s45, 7
    s_add_u32 s43, s42, 6
    s_lshr_b32 s42, s42, 2
    s_lshr_b32 s43, s43, 2
    s_sub_u32 s47, s43, s42
    s_add_u32 s47, s47, 1
    s_lshl_b32 s47, s47, 3
    s_cmp_lg_u32 s30, 0
    s_cbranch_scc1 skw_w
    s_lshl_b32 s60, s45, 8
    s_add_u32 s60, s60, 3985408
    v_mov_b32 v10, 0
    s_mov_b32 s61, 0
skw_poll:
    buffer_load_dword v11, v10, s[32:35], s60 offen sc1
    s_waitcnt vmcnt(0)
    v_readfirstlane_b32 s62, v11
    s_add_u32 s61, s61, 1
    s_nop 2
    s_cmp_eq_u32 s62, s47
    s_cbranch_scc1 skw_done
    s_cmp_lt_u32 s61, 400000
    s_cbranch_scc1 skw_poll
skw_done:
skw_w:
    s_waitcnt vmcnt(0)
    s_barrier
    s_cmp_lg_u32 s30, 0
    s_cbranch_scc1 s2a_skip
    s_lshl_b32 s60, s63, 8
    s_add_u32 s60, s60, 3989504
    v_mov_b32 v10, 0
    v_mov_b32 v11, 1
    s_mov_b64 exec, 1
    buffer_atomic_add v11, v10, s[32:35], s60 offen
    s_mov_b64 exec, -1
s2a_skip:
    s_add_u32 m0, s41, 0
    s_add_u32 s42, s40, 0
    buffer_load_dwordx4 v2, s[32:35], s42 offen offset:0 sc1 lds
    buffer_load_dwordx4 v2, s[32:35], s42 offen offset:1024 sc1 lds
    buffer_load_dwordx4 v2, s[32:35], s42 offen offset:2048 sc1 lds
    buffer_load_dwordx4 v2, s[32:35], s42 offen offset:3072 sc1 lds
    s_add_u32 m0, s41, 16384
    s_add_u32 s42, s40, 28672
    buffer_load_dwordx4 v2, s[32:35], s42 offen offset:0 sc1 lds
    buffer_load_dwordx4 v2, s[32:35], s42 offen offset:1024 sc1 lds
    buffer_load_dwordx4 v2, s[32:35], s42 offen offset:2048 sc1 lds
    buffer_load_dwordx4 v2, s[32:35], s42 offen offset:3072 sc1 lds
    s_add_u32 m0, s41, 32768
    s_add_u32 s42, s40, 57344
    buffer_load_dwordx4 v2, s[32:35], s42 offen offset:0 sc1 lds
    buffer_load_dwordx4 v2, s[32:35], s42 offen offset:1024 sc1 lds
    buffer_load_dwordx4 v2, s[32:35], s42 offen offset:2048 sc1 lds
    buffer_load_dwordx4 v2, s[32:35], s42 offen offset:3072 sc1 lds
    s_cmp_lg_u32 s30, 0
    s_cbranch_scc1 s2w_w
    s_lshl_b32 s60, s44, 8
    s_add_u32 s60, s60, 3989504
    v_mov_b32 v10, 0
    s_mov_b32 s61, 0
s2w_poll:
    buffer_load_dword v11, v10, s[32:35], s60 offen sc1
    s_waitcnt vmcnt(0)
    v_readfirstlane_b32 s62, v11
    s_add_u32 s61, s61, 1
    s_nop 2
    s_cmp_eq_u32 s62, 16
    s_cbranch_scc1 s2w_done
    s_cmp_lt_u32 s61, 400000
    s_cbranch_scc1 s2w_poll
s2w_done:
s2w_w:
    s_barrier
    s_lshl_b32 s43, s46, 15
    s_add_u32 s43, s43, 8388608
    s_add_u32 s48, s43, 0
    buffer_load_dwordx4 a[0:3], v2, s[32:35], s48 offen offset:0 sc1
    buffer_load_dwordx4 a[4:7], v2, s[32:35], s48 offen offset:1024 sc1
    buffer_load_dwordx4 a[8:11], v2, s[32:35], s48 offen offset:2048 sc1
    buffer_load_dwordx4 a[12:15], v2, s[32:35], s48 offen offset:3072 sc1
    s_add_u32 s48, s43, 4096
    buffer_load_dwordx4 a[16:19], v2, s[32:35], s48 offen offset:0 sc1
    buffer_load_dwordx4 a[20:23], v2, s[32:35], s48 offen offset:1024 sc1
    buffer_load_dwordx4 a[24:27], v2, s[32:35], s48 offen offset:2048 sc1
    buffer_load_dwordx4 a[28:31], v2, s[32:35], s48 offen offset:3072 sc1
    s_add_u32 s48, s43, 8192
    buffer_load_dwordx4 a[32:35], v2, s[32:35], s48 offen offset:0 sc1
    buffer_load_dwordx4 a[36:39], v2, s[32:35], s48 offen offset:1024 sc1
    buffer_load_dwordx4 a[40:43], v2, s[32:35], s48 offen offset:2048 sc1
    buffer_load_dwordx4 a[44:47], v2, s[32:35], s48 offen offset:3072 sc1
    s_mul_i32 s49, s45, 1792
    s_add_u32 s49, s49, 3874816
    s_and_b32 s50, s30, 1
    s_lshl_b32 s50, s50, 10
    s_add_u32 s49, s49, s50
    s_add_u32 s50, s50, 131072
    v_and_b32 v3, 31, v1
    v_lshlrev_b32 v3, 3, v3
    s_lshl_b32 s51, s46, 8
    s_add_u32 s51, s51, 12582912
    s_lshl_b32 s53, s2, 2
    s_add_u32 s53, s53, s30
    s_lshl_b32 s53, s53, 11
    v_add_u32 v8, s53, v2
    v_add_u32 v9, 1024, v8
    v_min_u32 v8, 1834992, v8
    v_min_u32 v9, 1834992, v9
    v_lshrrev_b32 v12, 3, v1
    v_lshlrev_b32 v12, 10, v12
    v_and_b32 v13, 7, v1
    v_lshl_add_u32 v12, v13, 4, v12
    s_lshr_b32 s60, s2, 3
    s_mul_i32 s60, s60, 57344
    s_lshl_b32 s61, s30, 14
    s_add_u32 s60, s60, s61
    v_add_u32 v12, s60, v12
    v_add_u32 v7, 0x10000, v2
    v_lshrrev_b32 v11, 5, v1
    v_lshlrev_b32 v11, 4, v11
    v_add_u32 v11, 131072, v11
    s_mul_i32 s54, s46, 114688
    s_mul_i32 s55, s45, 7168
    s_add_u32 s54, s54, s55
    s_add_u32 s54, s54, 17825792
    s_add_u32 s55, s54, 4096
    s_lshl_b32 s56, s44, 8
    s_add_u32 s57, s56, 3997696
    s_add_u32 s56, s56, 3993600
    s_and_b32 s58, s2, 7
    s_lshl_b32 s58, s58, 1
    s_lshr_b32 s59, s2, 7
    s_add_u32 s58, s58, s59
    s_lshl_b32 s58, s58, 8
    s_add_u32 s59, s58, 3997696
    s_add_u32 s58, s58, 3993600
    s_waitcnt vmcnt(8)
    s_barrier
    ds_read_b128 v[128:131], v2 offset:0
    ds_read_b128 v[132:135], v2 offset:1024
    ds_read_b128 v[136:139], v2 offset:2048
    ds_read_b128 v[140:143], v2 offset:3072
    s_waitcnt lgkmcnt(0)
    v_mfma_f32_32x32x16_bf16 v[16:31], v[128:131], a[0:3], 0
    ds_read_b128 v[144:147], v2 offset:4096
    ds_read_b128 v[148:151], v2 offset:5120
    v_mfma_f32_32x32x16_bf16 v[32:47], v[132:135], a[0:3], 0
    ds_read_b128 v[152:155], v2 offset:6144
    ds_read_b128 v[156:159], v2 offset:7168
    s_add_u32 m0, s41, 49152
    s_add_u32 s42, s40, 86016
    buffer_load_dwordx4 v2, s[32:35], s42 offen offset:0 sc1 lds
    v_mfma_f32_32x32x16_bf16 v[48:63], v[136:139], a[0:3], 0
    v_mfma_f32_32x32x16_bf16 v[64:79], v[140:143], a[0:3], 0
    buffer_load_dwordx4 v2, s[32:35], s42 offen offset:1024 sc1 lds
    s_waitcnt lgkmcnt(0)
    v_mfma_f32_32x32x16_bf16 v[16:31], v[144:147], a[4:7], v[16:31]
    ds_read_b128 v[128:131], v2 offset:8192
    ds_read_b128 v[132:135], v2 offset:9216
    v_mfma_f32_32x32x16_bf16 v[32:47], v[148:151], a[4:7], v[32:47]
    ds_read_b128 v[136:139], v2 offset:10240
    ds_read_b128 v[140:143], v2 offset:11264
    buffer_load_dwordx4 v2, s[32:35], s42 offen offset:2048 sc1 lds
    v_mfma_f32_32x32x16_bf16 v[48:63], v[152:155], a[4:7], v[48:63]
    v_mfma_f32_32x32x16_bf16 v[64:79], v[156:159], a[4:7], v[64:79]
    buffer_load_dwordx4 v2, s[32:35], s42 offen offset:3072 sc1 lds
    s_waitcnt lgkmcnt(0)
    v_mfma_f32_32x32x16_bf16 v[16:31], v[128:131], a[8:11], v[16:31]
    ds_read_b128 v[144:147], v2 offset:12288
    ds_read_b128 v[148:151], v2 offset:13312
    v_mfma_f32_32x32x16_bf16 v[32:47], v[132:135], a[8:11], v[32:47]
    ds_read_b128 v[152:155], v2 offset:14336
    ds_read_b128 v[156:159], v2 offset:15360
    s_add_u32 s48, s43, 12288
    buffer_load_dwordx4 a[48:51], v2, s[32:35], s48 offen offset:0 sc1
    v_mfma_f32_32x32x16_bf16 v[48:63], v[136:139], a[8:11], v[48:63]
    v_mfma_f32_32x32x16_bf16 v[64:79], v[140:143], a[8:11], v[64:79]
    buffer_load_dwordx4 a[52:55], v2, s[32:35], s48 offen offset:1024 sc1
    s_waitcnt lgkmcnt(0)
    s_waitcnt vmcnt(10)
    s_barrier
    v_mfma_f32_32x32x16_bf16 v[16:31], v[144:147], a[12:15], v[16:31]
    ds_read_b128 v[128:131], v2 offset:16384
    ds_read_b128 v[132:135], v2 offset:17408
    v_mfma_f32_32x32x16_bf16 v[32:47], v[148:151], a[12:15], v[32:47]
    ds_read_b128 v[136:139], v2 offset:18432
    ds_read_b128 v[140:143], v2 offset:19456
    buffer_load_dwordx4 a[56:59], v2, s[32:35], s48 offen offset:2048 sc1
    v_mfma_f32_32x32x16_bf16 v[48:63], v[152:155], a[12:15], v[48:63]
    v_mfma_f32_32x32x16_bf16 v[64:79], v[156:159], a[12:15], v[64:79]
    buffer_load_dwordx4 a[60:63], v2, s[32:35], s48 offen offset:3072 sc1
    s_waitcnt lgkmcnt(0)
    v_mfma_f32_32x32x16_bf16 v[16:31], v[128:131], a[16:19], v[16:31]
    ds_read_b128 v[144:147], v2 offset:20480
    ds_read_b128 v[148:151], v2 offset:21504
    v_mfma_f32_32x32x16_bf16 v[32:47], v[132:135], a[16:19], v[32:47]
    ds_read_b128 v[152:155], v2 offset:22528
    ds_read_b128 v[156:159], v2 offset:23552
    s_add_u32 m0, s41, 65536
    s_add_u32 s42, s40, 114688
    buffer_load_dwordx4 v2, s[32:35], s42 offen offset:0 sc1 lds
    v_mfma_f32_32x32x16_bf16 v[48:63], v[136:139], a[16:19], v[48:63]
    v_mfma_f32_32x32x16_bf16 v[64:79], v[140:143], a[16:19], v[64:79]
    buffer_load_dwordx4 v2, s[32:35], s42 offen offset:1024 sc1 lds
    s_waitcnt lgkmcnt(0)
    v_mfma_f32_32x32x16_bf16 v[16:31], v[144:147], a[20:23], v[16:31]
    ds_read_b128 v[128:131], v2 offset:24576
    ds_read_b128 v[132:135], v2 offset:25600
    v_mfma_f32_32x32x16_bf16 v[32:47], v[148:151], a[20:23], v[32:47]
    ds_read_b128 v[136:139], v2 offset:26624
    ds_read_b128 v[140:143], v2 offset:27648
    buffer_load_dwordx4 v2, s[32:35], s42 offen offset:2048 sc1 lds
    v_mfma_f32_32x32x16_bf16 v[48:63], v[152:155], a[20:23], v[48:63]
    v_mfma_f32_32x32x16_bf16 v[64:79], v[156:159], a[20:23], v[64:79]
    buffer_load_dwordx4 v2, s[32:35], s42 offen offset:3072 sc1 lds
    s_waitcnt lgkmcnt(0)
    v_mfma_f32_32x32x16_bf16 v[16:31], v[128:131], a[24:27], v[16:31]
    ds_read_b128 v[144:147], v2 offset:28672
    ds_read_b128 v[148:151], v2 offset:29696
    v_mfma_f32_32x32x16_bf16 v[32:47], v[132:135], a[24:27], v[32:47]
    ds_read_b128 v[152:155], v2 offset:30720
    ds_read_b128 v[156:159], v2 offset:31744
    s_add_u32 s48, s43, 16384
    buffer_load_dwordx4 a[64:67], v2, s[32:35], s48 offen offset:0 sc1
    v_mfma_f32_32x32x16_bf16 v[48:63], v[136:139], a[24:27], v[48:63]
    v_mfma_f32_32x32x16_bf16 v[64:79], v[140:143], a[24:27], v[64:79]
    buffer_load_dwordx4 a[68:71], v2, s[32:35], s48 offen offset:1024 sc1
    s_waitcnt lgkmcnt(0)
    s_waitcnt vmcnt(14)
    s_barrier
    v_mfma_f32_32x32x16_bf16 v[16:31], v[144:147], a[28:31], v[16:31]
    ds_read_b128 v[128:131], v2 offset:32768
    ds_read_b128 v[132:135], v2 offset:33792
    v_mfma_f32_32x32x16_bf16 v[32:47], v[148:151], a[28:31], v[32:47]
    ds_read_b128 v[136:139], v2 offset:34816
    ds_read_b128 v[140:143], v2 offset:35840
    buffer_load_dwordx4 a[72:75], v2, s[32:35], s48 offen offset:2048 sc1
    v_mfma_f32_32x32x16_bf16 v[48:63], v[152:155], a[28:31], v[48:63]
    v_mfma_f32_32x32x16_bf16 v[64:79], v[156:159], a[28:31], v[64:79]
    buffer_load_dwordx4 a[76:79], v2, s[32:35], s48 offen offset:3072 sc1
    s_waitcnt lgkmcnt(0)
    v_mfma_f32_32x32x16_bf16 v[16:31], v[128:131], a[32:35], v[16:31]
    ds_read_b128 v[144:147], v2 offset:36864
    ds_read_b128 v[148:151], v2 offset:37888
    v_mfma_f32_32x32x16_bf16 v[32:47], v[132:135], a[32:35], v[32:47]
    ds_read_b128 v[152:155], v2 offset:38912
    ds_read_b128 v[156:159], v2 offset:39936
    s_add_u32 m0, s41, 81920
    s_add_u32 s42, s40, 143360
    buffer_load_dwordx4 v2, s[32:35], s42 offen offset:0 sc1 lds
    v_mfma_f32_32x32x16_bf16 v[48:63], v[136:139], a[32:35], v[48:63]
    v_mfma_f32_32x32x16_bf16 v[64:79], v[140:143], a[32:35], v[64:79]
    buffer_load_dwordx4 v2, s[32:35], s42 offen offset:1024 sc1 lds
    s_waitcnt lgkmcnt(0)
    v_mfma_f32_32x32x16_bf16 v[16:31], v[144:147], a[36:39], v[16:31]
    ds_read_b128 v[128:131], v2 offset:40960
    ds_read_b128 v[132:135], v2 offset:41984
    v_mfma_f32_32x32x16_bf16 v[32:47], v[148:151], a[36:39], v[32:47]
    ds_read_b128 v[136:139], v2 offset:43008
    ds_read_b128 v[140:143], v2 offset:44032
    buffer_load_dwordx4 v2, s[32:35], s42 offen offset:2048 sc1 lds
    v_mfma_f32_32x32x16_bf16 v[48:63], v[152:155], a[36:39], v[48:63]
    v_mfma_f32_32x32x16_bf16 v[64:79], v[156:159], a[36:39], v[64:79]
    buffer_load_dwordx4 v2, s[32:35], s42 offen offset:3072 sc1 lds
    s_waitcnt lgkmcnt(0)
    v_mfma_f32_32x32x16_bf16 v[16:31], v[128:131], a[40:43], v[16:31]
    ds_read_b128 v[144:147], v2 offset:45056
    ds_read_b128 v[148:151], v2 offset:46080
    v_mfma_f32_32x32x16_bf16 v[32:47], v[132:135], a[40:43], v[32:47]
    ds_read_b128 v[152:155], v2 offset:47104
    ds_read_b128 v[156:159], v2 offset:48128
    s_add_u32 s48, s43, 20480
    buffer_load_dwordx4 a[80:83], v2, s[32:35], s48 offen offset:0 sc1
    v_mfma_f32_32x32x16_bf16 v[48:63], v[136:139], a[40:43], v[48:63]
    v_mfma_f32_32x32x16_bf16 v[64:79], v[140:143], a[40:43], v[64:79]
    buffer_load_dwordx4 a[84:87], v2, s[32:35], s48 offen offset:1024 sc1
    s_waitcnt lgkmcnt(0)
    s_waitcnt vmcnt(14)
    s_barrier
    v_mfma_f32_32x32x16_bf16 v[16:31], v[144:147], a[44:47], v[16:31]
    ds_read_b128 v[128:131], v2 offset:49152
    ds_read_b128 v[132:135], v2 offset:50176
    v_mfma_f32_32x32x16_bf16 v[32:47], v[148:151], a[44:47], v[32:47]
    ds_read_b128 v[136:139], v2 offset:51200
    ds_read_b128 v[140:143], v2 offset:52224
    buffer_load_dwordx4 a[88:91], v2, s[32:35], s48 offen offset:2048 sc1
    v_mfma_f32_32x32x16_bf16 v[48:63], v[152:155], a[44:47], v[48:63]
    v_mfma_f32_32x32x16_bf16 v[64:79], v[156:159], a[44:47], v[64:79]
    buffer_load_dwordx4 a[92:95], v2, s[32:35], s48 offen offset:3072 sc1
    s_waitcnt lgkmcnt(0)
    v_mfma_f32_32x32x16_bf16 v[16:31], v[128:131], a[48:51], v[16:31]
    ds_read_b128 v[144:147], v2 offset:53248
    ds_read_b128 v[148:151], v2 offset:54272
    v_mfma_f32_32x32x16_bf16 v[32:47], v[132:135], a[48:51], v[32:47]
    ds_read_b128 v[152:155], v2 offset:55296
    ds_read_b128 v[156:159], v2 offset:56320
    s_add_u32 m0, s41, 98304
    s_add_u32 s42, s40, 172032
    buffer_load_dwordx4 v2, s[32:35], s42 offen offset:0 sc1 lds
    v_mfma_f32_32x32x16_bf16 v[48:63], v[136:139], a[48:51], v[48:63]
    v_mfma_f32_32x32x16_bf16 v[64:79], v[140:143], a[48:51], v[64:79]
    buffer_load_dwordx4 v2, s[32:35], s42 offen offset:1024 sc1 lds
    s_waitcnt lgkmcnt(0)
    v_mfma_f32_32x32x16_bf16 v[16:31], v[144:147], a[52:55], v[16:31]
    ds_read_b128 v[128:131], v2 offset:57344
    ds_read_b128 v[132:135], v2 offset:58368
    v_mfma_f32_32x32x16_bf16 v[32:47], v[148:151], a[52:55], v[32:47]
    ds_read_b128 v[136:139], v2 offset:59392
    ds_read_b128 v[140:143], v2 offset:60416
    buffer_load_dwordx4 v2, s[32:35], s42 offen offset:2048 sc1 lds
    v_mfma_f32_32x32x16_bf16 v[48:63], v[152:155], a[52:55], v[48:63]
    v_mfma_f32_32x32x16_bf16 v[64:79], v[156:159], a[52:55], v[64:79]
    buffer_load_dwordx4 v2, s[32:35], s42 offen offset:3072 sc1 lds
    s_waitcnt lgkmcnt(0)
    v_mfma_f32_32x32x16_bf16 v[16:31], v[128:131], a[56:59], v[16:31]
    ds_read_b128 v[144:147], v2 offset:61440
    ds_read_b128 v[148:151], v2 offset:62464
    v_mfma_f32_32x32x16_bf16 v[32:47], v[132:135], a[56:59], v[32:47]
    ds_read_b128 v[152:155], v2 offset:63488
    ds_read_b128 v[156:159], v2 offset:64512
    s_add_u32 s48, s43, 24576
    buffer_load_dwordx4 a[96:99], v2, s[32:35], s48 offen offset:0 sc1
    v_mfma_f32_32x32x16_bf16 v[48:63], v[136:139], a[56:59], v[48:63]
    v_mfma_f32_32x32x16_bf16 v[64:79], v[140:143], a[56:59], v[64:79]
    buffer_load_dwordx4 a[100:103], v2, s[32:35], s48 offen offset:1024 sc1
    s_waitcnt lgkmcnt(0)
    s_waitcnt vmcnt(14)
    s_barrier
    v_mfma_f32_32x32x16_bf16 v[16:31], v[144:147], a[60:63], v[16:31]
    ds_read_b128 v[128:131], v7 offset:0
    ds_read_b128 v[132:135], v7 offset:1024
    v_mfma_f32_32x32x16_bf16 v[32:47], v[148:151], a[60:63], v[32:47]
    ds_read_b128 v[136:139], v7 offset:2048
    ds_read_b128 v[140:143], v7 offset:3072
    buffer_load_dwordx4 a[104:107], v2, s[32:35], s48 offen offset:2048 sc1
    v_mfma_f32_32x32x16_bf16 v[48:63], v[152:155], a[60:63], v[48:63]
    v_mfma_f32_32x32x16_bf16 v[64:79], v[156:159], a[60:63], v[64:79]
    buffer_load_dwordx4 a[108:111], v2, s[32:35], s48 offen offset:3072 sc1
    s_waitcnt lgkmcnt(0)
    v_mfma_f32_32x32x16_bf16 v[16:31], v[128:131], a[64:67], v[16:31]
    ds_read_b128 v[144:147], v7 offset:4096
    ds_read_b128 v[148:151], v7 offset:5120
    v_mfma_f32_32x32x16_bf16 v[32:47], v[132:135], a[64:67], v[32:47]
    ds_read_b128 v[152:155], v7 offset:6144
    ds_read_b128 v[156:159], v7 offset:7168
    s_add_u32 m0, s41, 114688
    s_add_u32 s42, s40, 200704
    buffer_load_dwordx4 v2, s[32:35], s42 offen offset:0 sc1 lds
    v_mfma_f32_32x32x16_bf16 v[48:63], v[136:139], a[64:67], v[48:63]
    v_mfma_f32_32x32x16_bf16 v[64:79], v[140:143], a[64:67], v[64:79]
    buffer_load_dwordx4 v2, s[32:35], s42 offen offset:1024 sc1 lds
    s_waitcnt lgkmcnt(0)
    v_mfma_f32_32x32x16_bf16 v[16:31], v[144:147], a[68:71], v[16:31]
    ds_read_b128 v[128:131], v7 offset:8192
    ds_read_b128 v[132:135], v7 offset:9216
    v_mfma_f32_32x32x16_bf16 v[32:47], v[148:151], a[68:71], v[32:47]
    ds_read_b128 v[136:139], v7 offset:10240
    ds_read_b128 v[140:143], v7 offset:11264
    buffer_load_dwordx4 v2, s[32:35], s42 offen offset:2048 sc1 lds
    v_mfma_f32_32x32x16_bf16 v[48:63], v[152:155], a[68:71], v[48:63]
    v_mfma_f32_32x32x16_bf16 v[64:79], v[156:159], a[68:71], v[64:79]
    buffer_load_dwordx4 v2, s[32:35], s42 offen offset:3072 sc1 lds
    s_waitcnt lgkmcnt(0)
    v_mfma_f32_32x32x16_bf16 v[16:31], v[128:131], a[72:75], v[16:31]
    ds_read_b128 v[144:147], v7 offset:12288
    ds_read_b128 v[148:151], v7 offset:13312
    v_mfma_f32_32x32x16_bf16 v[32:47], v[132:135], a[72:75], v[32:47]
    ds_read_b128 v[152:155], v7 offset:14336
    ds_read_b128 v[156:159], v7 offset:15360
    s_add_u32 s48, s43, 28672
    buffer_load_dwordx4 a[112:115], v2, s[32:35], s48 offen offset:0 sc1
    v_mfma_f32_32x32x16_bf16 v[48:63], v[136:139], a[72:75], v[48:63]
    v_mfma_f32_32x32x16_bf16 v[64:79], v[140:143], a[72:75], v[64:79]
    buffer_load_dwordx4 a[116:119], v2, s[32:35], s48 offen offset:1024 sc1
    s_waitcnt lgkmcnt(0)
    s_waitcnt vmcnt(14)
    s_barrier
    v_mfma_f32_32x32x16_bf16 v[16:31], v[144:147], a[76:79], v[16:31]
    ds_read_b128 v[128:131], v7 offset:16384
    ds_read_b128 v[132:135], v7 offset:17408
    v_mfma_f32_32x32x16_bf16 v[32:47], v[148:151], a[76:79], v[32:47]
    ds_read_b128 v[136:139], v7 offset:18432
    ds_read_b128 v[140:143], v7 offset:19456
    buffer_load_dwordx4 a[120:123], v2, s[32:35], s48 offen offset:2048 sc1
    v_mfma_f32_32x32x16_bf16 v[48:63], v[152:155], a[76:79], v[48:63]
    v_mfma_f32_32x32x16_bf16 v[64:79], v[156:159], a[76:79], v[64:79]
    buffer_load_dwordx4 a[124:127], v2, s[32:35], s48 offen offset:3072 sc1
    s_waitcnt lgkmcnt(0)
    v_mfma_f32_32x32x16_bf16 v[16:31], v[128:131], a[80:83], v[16:31]
    ds_read_b128 v[144:147], v7 offset:20480
    ds_read_b128 v[148:151], v7 offset:21504
    v_mfma_f32_32x32x16_bf16 v[32:47], v[132:135], a[80:83], v[32:47]
    ds_read_b128 v[152:155], v7 offset:22528
    ds_read_b128 v[156:159], v7 offset:23552
    s_add_u32 m0, s41, 0
    s_add_u32 s42, s40, 4096
    buffer_load_dwordx4 v2, s[32:35], s42 offen offset:0 sc1 lds
    v_mfma_f32_32x32x16_bf16 v[48:63], v[136:139], a[80:83], v[48:63]
    v_mfma_f32_32x32x16_bf16 v[64:79], v[140:143], a[80:83], v[64:79]
    buffer_load_dwordx4 v2, s[32:35], s42 offen offset:1024 sc1 lds
    s_waitcnt lgkmcnt(0)
    v_mfma_f32_32x32x16_bf16 v[16:31], v[144:147], a[84:87], v[16:31]
    ds_read_b128 v[128:131], v7 offset:24576
    ds_read_b128 v[132:135], v7 offset:25600
    v_mfma_f32_32x32x16_bf16 v[32:47], v[148:151], a[84:87], v[32:47]
    ds_read_b128 v[136:139], v7 offset:26624
    ds_read_b128 v[140:143], v7 offset:27648
    buffer_load_dwordx4 v2, s[32:35], s42 offen offset:2048 sc1 lds
    v_mfma_f32_32x32x16_bf16 v[48:63], v[152:155], a[84:87], v[48:63]
    v_mfma_f32_32x32x16_bf16 v[64:79], v[156:159], a[84:87], v[64:79]
    s_add_u32 m0, s41, 16384
    s_add_u32 s42, s40, 32768
    buffer_load_dwordx4 v2, s[32:35], s42 offen offset:0 sc1 lds
    s_waitcnt lgkmcnt(0)
    v_mfma_f32_32x32x16_bf16 v[16:31], v[128:131], a[88:91], v[16:31]
    ds_read_b128 v[144:147], v7 offset:28672
    ds_read_b128 v[148:151], v7 offset:29696
    v_mfma_f32_32x32x16_bf16 v[32:47], v[132:135], a[88:91], v[32:47]
    ds_read_b128 v[152:155], v7 offset:30720
    ds_read_b128 v[156:159], v7 offset:31744
    buffer_load_dwordx4 v2, s[32:35], s42 offen offset:1024 sc1 lds
    v_mfma_f32_32x32x16_bf16 v[48:63], v[136:139], a[88:91], v[48:63]
    v_mfma_f32_32x32x16_bf16 v[64:79], v[140:143], a[88:91], v[64:79]
    buffer_load_dwordx4 v2, s[32:35], s42 offen offset:2048 sc1 lds
    s_waitcnt lgkmcnt(0)
    s_waitcnt vmcnt(14)
    s_barrier
    v_mfma_f32_32x32x16_bf16 v[16:31], v[144:147], a[92:95], v[16:31]
    ds_read_b128 v[128:131], v7 offset:32768
    ds_read_b128 v[132:135], v7 offset:33792
    v_mfma_f32_32x32x16_bf16 v[32:47], v[148:151], a[92:95], v[32:47]
    ds_read_b128 v[136:139], v7 offset:34816
    ds_read_b128 v[140:143], v7 offset:35840
    s_mov_b32 m0, s50
    s_nop 0
    buffer_load_dwordx4 v2, s[32:35], s49 offen sc1 lds
    v_mfma_f32_32x32x16_bf16 v[48:63], v[152:155], a[92:95], v[48:63]
    v_mfma_f32_32x32x16_bf16 v[64:79], v[156:159], a[92:95], v[64:79]
    s_add_u32 s53, s51, 0
    buffer_load_dwordx2 v[184:185], v3, s[32:35], s53 offen sc1
    s_waitcnt lgkmcnt(0)
    v_mfma_f32_32x32x16_bf16 v[16:31], v[128:131], a[96:99], v[16:31]
    ds_read_b128 v[144:147], v7 offset:36864
    ds_read_b128 v[148:151], v7 offset:37888
    v_mfma_f32_32x32x16_bf16 v[32:47], v[132:135], a[96:99], v[32:47]
    ds_read_b128 v[152:155], v7 offset:38912
    ds_read_b128 v[156:159], v7 offset:39936
    s_add_u32 s53, s51, 16384
    buffer_load_dwordx2 v[186:187], v3, s[32:35], s53 offen sc1
    v_mfma_f32_32x32x16_bf16 v[48:63], v[136:139], a[96:99], v[48:63]
    v_mfma_f32_32x32x16_bf16 v[64:79], v[140:143], a[96:99], v[64:79]
    s_add_u32 s53, s51, 32768
    buffer_load_dwordx2 v[188:189], v3, s[32:35], s53 offen sc1
    s_waitcnt lgkmcnt(0)
    v_mfma_f32_32x32x16_bf16 v[16:31], v[144:147], a[100:103], v[16:31]
    ds_read_b128 v[128:131], v7 offset:40960
    ds_read_b128 v[132:135], v7 offset:41984
    v_mfma_f32_32x32x16_bf16 v[32:47], v[148:151], a[100:103], v[32:47]
    ds_read_b128 v[136:139], v7 offset:43008
    ds_read_b128 v[140:143], v7 offset:44032
    s_add_u32 s53, s51, 49152
    buffer_load_dwordx2 v[190:191], v3, s[32:35], s53 offen sc1
    v_mfma_f32_32x32x16_bf16 v[48:63], v[152:155], a[100:103], v[48:63]
    v_mfma_f32_32x32x16_bf16 v[64:79], v[156:159], a[100:103], v[64:79]
    s_add_u32 s53, s51, 65536
    buffer_load_dwordx2 v[192:193], v3, s[32:35], s53 offen sc1
    s_waitcnt lgkmcnt(0)
    v_mfma_f32_32x32x16_bf16 v[16:31], v[128:131], a[104:107], v[16:31]
    ds_read_b128 v[144:147], v7 offset:45056
    ds_read_b128 v[148:151], v7 offset:46080
    v_mfma_f32_32x32x16_bf16 v[32:47], v[132:135], a[104:107], v[32:47]
    ds_read_b128 v[152:155], v7 offset:47104
    ds_read_b128 v[156:159], v7 offset:48128
    s_add_u32 s53, s51, 81920
    buffer_load_dwordx2 v[194:195], v3, s[32:35], s53 offen sc1
    v_mfma_f32_32x32x16_bf16 v[48:63], v[136:139], a[104:107], v[48:63]
    v_mfma_f32_32x32x16_bf16 v[64:79], v[140:143], a[104:107], v[64:79]
    s_add_u32 s53, s51, 98304
    buffer_load_dwordx2 v[196:197], v3, s[32:35], s53 offen sc1
    s_waitcnt lgkmcnt(0)
    s_waitcnt vmcnt(14)
    s_barrier
    v_mfma_f32_32x32x16_bf16 v[16:31], v[144:147], a[108:111], v[16:31]
    ds_read_b128 v[128:131], v7 offset:49152
    ds_read_b128 v[132:135], v7 offset:50176
    v_mfma_f32_32x32x16_bf16 v[32:47], v[148:151], a[108:111], v[32:47]
    ds_read_b128 v[136:139], v7 offset:51200
    ds_read_b128 v[140:143], v7 offset:52224
    s_add_u32 s53, s51, 114688
    buffer_load_dwordx2 v[198:199], v3, s[32:35], s53 offen sc1
    v_mfma_f32_32x32x16_bf16 v[48:63], v[152:155], a[108:111], v[48:63]
    v_mfma_f32_32x32x16_bf16 v[64:79], v[156:159], a[108:111], v[64:79]
    global_load_dwordx4 a[232:235], v8, s[18:19]
    s_waitcnt lgkmcnt(0)
    v_mfma_f32_32x32x16_bf16 v[16:31], v[128:131], a[112:115], v[16:31]
    ds_read_b128 v[144:147], v7 offset:53248
    ds_read_b128 v[148:151], v7 offset:54272
    v_mfma_f32_32x32x16_bf16 v[32:47], v[132:135], a[112:115], v[32:47]
    ds_read_b128 v[152:155], v7 offset:55296
    ds_read_b128 v[156:159], v7 offset:56320
    global_load_dwordx4 a[232:235], v9, s[18:19]
    v_mfma_f32_32x32x16_bf16 v[48:63], v[136:139], a[112:115], v[48:63]
    v_mfma_f32_32x32x16_bf16 v[64:79], v[140:143], a[112:115], v[64:79]
    s_add_u32 m0, s41, 32768
    s_add_u32 s42, s40, 61440
    buffer_load_dwordx4 v2, s[32:35], s42 offen offset:0 sc1 lds
    s_waitcnt lgkmcnt(0)
    v_mfma_f32_32x32x16_bf16 v[16:31], v[144:147], a[116:119], v[16:31]
    ds_read_b128 v[128:131], v7 offset:57344
    ds_read_b128 v[132:135], v7 offset:58368
    v_mfma_f32_32x32x16_bf16 v[32:47], v[148:151], a[116:119], v[32:47]
    ds_read_b128 v[136:139], v7 offset:59392
    ds_read_b128 v[140:143], v7 offset:60416
    buffer_load_dwordx4 v2, s[32:35], s42 offen offset:1024 sc1 lds
    v_mfma_f32_32x32x16_bf16 v[48:63], v[152:155], a[116:119], v[48:63]
    v_mfma_f32_32x32x16_bf16 v[64:79], v[156:159], a[116:119], v[64:79]
    buffer_load_dwordx4 v2, s[32:35], s42 offen offset:2048 sc1 lds
    s_waitcnt lgkmcnt(0)
    s_waitcnt vmcnt(5)
    v_pk_add_f32 v[200:201], v[184:185], v[186:187]
    v_pk_add_f32 v[202:203], v[188:189], v[190:191]
    v_pk_add_f32 v[200:201], v[200:201], v[192:193]
    v_pk_add_f32 v[202:203], v[202:203], v[194:195]
    v_pk_add_f32 v[200:201], v[200:201], v[196:197]
    v_pk_add_f32 v[202:203], v[202:203], v[198:199]
    v_pk_add_f32 v[200:201], v[200:201], v[202:203]
    s_mov_b32 s52, 0x3b000000
    v_mul_f32 v200, s52, v200
    v_mul_f32 v201, s52, v201
    v_fma_f32 v201, -v200, v200, v201
    v_max_f32 v201, 0, v201
    v_add_f32 v201, 0x3727c5ac, v201
    v_rsq_f32 v201, v201
    s_nop 0
    v_mul_f32 v202, v200, v201
    v_sub_f32 v202, 0, v202
    v_mov_b32 v200, v201
    v_mfma_f32_32x32x16_bf16 v[16:31], v[128:131], a[120:123], v[16:31]
    ds_read_b128 v[144:147], v7 offset:61440
    ds_read_b128 v[148:151], v7 offset:62464
    v_mfma_f32_32x32x16_bf16 v[32:47], v[132:135], a[120:123], v[32:47]
    ds_read_b128 v[152:155], v7 offset:63488
    ds_read_b128 v[156:159], v7 offset:64512
    s_add_u32 m0, s41, 49152
    s_add_u32 s42, s40, 90112
    buffer_load_dwordx4 v2, s[32:35], s42 offen offset:0 sc1 lds
    v_mfma_f32_32x32x16_bf16 v[48:63], v[136:139], a[120:123], v[48:63]
    v_mfma_f32_32x32x16_bf16 v[64:79], v[140:143], a[120:123], v[64:79]
    buffer_load_dwordx4 v2, s[32:35], s42 offen offset:1024 sc1 lds
    s_waitcnt lgkmcnt(0)
    s_barrier
    v_mfma_f32_32x32x16_bf16 v[16:31], v[144:147], a[124:127], v[16:31]
    ds_read_b128 v[128:131], v2 offset:0
    ds_read_b128 v[132:135], v2 offset:1024
    v_mfma_f32_32x32x16_bf16 v[32:47], v[148:151], a[124:127], v[32:47]
    ds_read_b128 v[136:139], v2 offset:2048
    buffer_load_dwordx4 v2, s[32:35], s42 offen offset:2048 sc1 lds
    v_mfma_f32_32x32x16_bf16 v[48:63], v[152:155], a[124:127], v[48:63]
    v_mfma_f32_32x32x16_bf16 v[64:79], v[156:159], a[124:127], v[64:79]
    s_add_u32 m0, s41, 65536
    s_add_u32 s42, s40, 118784
    buffer_load_dwordx4 v2, s[32:35], s42 offen offset:0 sc1 lds
    s_waitcnt lgkmcnt(0)
    v_mfma_f32_32x32x16_bf16 v[80:95], v[128:131], a[0:3], 0
    ds_read_b128 v[144:147], v2 offset:4096
    ds_read_b128 v[148:151], v2 offset:5120
    v_mfma_f32_32x32x16_bf16 v[96:111], v[132:135], a[0:3], 0
    ds_read_b128 v[152:155], v2 offset:6144
    buffer_load_dwordx4 v2, s[32:35], s42 offen offset:1024 sc1 lds
    v_mfma_f32_32x32x16_bf16 v[112:127], v[136:139], a[0:3], 0
    buffer_load_dwordx4 v2, s[32:35], s42 offen offset:2048 sc1 lds
    s_waitcnt lgkmcnt(0)
    v_mfma_f32_32x32x16_bf16 v[80:95], v[144:147], a[4:7], v[80:95]
    ds_read_b128 v[128:131], v2 offset:8192
    ds_read_b128 v[132:135], v2 offset:9216
    ds_read_b128 v[160:163], v11 offset:0
    ds_read_b128 v[176:179], v11 offset:128
    ds_read_b128 v[164:167], v11 offset:32
    ds_read_b128 v[180:183], v11 offset:160
    v_mfma_f32_32x32x16_bf16 v[96:111], v[148:151], a[4:7], v[96:111]
    ds_read_b128 v[136:139], v2 offset:10240
    s_add_u32 m0, s41, 81920
    s_add_u32 s42, s40, 147456
    buffer_load_dwordx4 v2, s[32:35], s42 offen offset:0 sc1 lds
    ds_read_b128 v[168:171], v11 offset:64
    ds_read_b128 v[184:187], v11 offset:192
    ds_read_b128 v[172:175], v11 offset:96
    v_mfma_f32_32x32x16_bf16 v[112:127], v[152:155], a[4:7], v[112:127]
    buffer_load_dwordx4 v2, s[32:35], s42 offen offset:1024 sc1 lds
    ds_read_b128 v[188:191], v11 offset:224
    s_waitcnt lgkmcnt(4)
    v_mfma_f32_32x32x16_bf16 v[80:95], v[128:131], a[8:11], v[80:95]
    ds_read_b128 v[144:147], v2 offset:12288
    ds_read_b128 v[148:151], v2 offset:13312
    s_waitcnt lgkmcnt(2)
    v_fma_f32 v160, v202, v160, v176
    v_fma_f32 v161, v202, v161, v177
    v_fma_f32 v162, v202, v162, v178
    v_mfma_f32_32x32x16_bf16 v[96:111], v[132:135], a[8:11], v[96:111]
    ds_read_b128 v[152:155], v2 offset:14336
    buffer_load_dwordx4 v2, s[32:35], s42 offen offset:2048 sc1 lds
    v_fma_f32 v163, v202, v163, v179
    v_fma_f32 v164, v202, v164, v180
    v_fma_f32 v165, v202, v165, v181
    v_mfma_f32_32x32x16_bf16 v[112:127], v[136:139], a[8:11], v[112:127]
    v_fma_f32 v166, v202, v166, v182
    v_fma_f32 v167, v202, v167, v183
    v_fma_f32 v168, v202, v168, v184
    s_waitcnt lgkmcnt(0)
    s_barrier
    v_mfma_f32_32x32x16_bf16 v[80:95], v[144:147], a[12:15], v[80:95]
    ds_read_b128 v[128:131], v2 offset:16384
    ds_read_b128 v[132:135], v2 offset:17408
    v_fma_f32 v169, v202, v169, v185
    v_fma_f32 v170, v202, v170, v186
    v_fma_f32 v171, v202, v171, v187
    v_fma_f32 v172, v202, v172, v188
    v_mfma_f32_32x32x16_bf16 v[96:111], v[148:151], a[12:15], v[96:111]
    ds_read_b128 v[136:139], v2 offset:18432
    v_fma_f32 v173, v202, v173, v189
    v_fma_f32 v174, v202, v174, v190
    v_fma_f32 v175, v202, v175, v191
    v_mfma_f32_32x32x16_bf16 v[112:127], v[152:155], a[12:15], v[112:127]
    v_fma_f32 v16, v200, v16, v160
    v_fma_f32 v17, v200, v17, v161
    v_fma_f32 v18, v200, v18, v162
    s_waitcnt lgkmcnt(0)
    v_mfma_f32_32x32x16_bf16 v[80:95], v[128:131], a[16:19], v[80:95]
    ds_read_b128 v[144:147], v2 offset:20480
    ds_read_b128 v[148:151], v2 offset:21504
    v_fma_f32 v19, v200, v19, v163
    v_fma_f32 v20, v200, v20, v164
    v_fma_f32 v21, v200, v21, v165
    v_fma_f32 v22, v200, v22, v166
    v_mfma_f32_32x32x16_bf16 v[96:111], v[132:135], a[16:19], v[96:111]
    ds_read_b128 v[152:155], v2 offset:22528
    s_add_u32 m0, s41, 98304
    s_add_u32 s42, s40, 176128
    buffer_load_dwordx4 v2, s[32:35], s42 offen offset:0 sc1 lds
    v_fma_f32 v23, v200, v23, v167
    v_fma_f32 v24, v200, v24, v168
    v_fma_f32 v25, v200, v25, v169
    v_mfma_f32_32x32x16_bf16 v[112:127], v[136:139], a[16:19], v[112:127]
    buffer_load_dwordx4 v2, s[32:35], s42 offen offset:1024 sc1 lds
    v_fma_f32 v26, v200, v26, v170
    v_fma_f32 v27, v200, v27, v171
    v_fma_f32 v28, v200, v28, v172
    s_waitcnt lgkmcnt(0)
    v_mfma_f32_32x32x16_bf16 v[80:95], v[144:147], a[20:23], v[80:95]
    ds_read_b128 v[128:131], v2 offset:24576
    ds_read_b128 v[132:135], v2 offset:25600
    v_fma_f32 v29, v200, v29, v173
    v_fma_f32 v30, v200, v30, v174
    v_fma_f32 v31, v200, v31, v175
    v_max_f32 v16, 0, v16
    v_mfma_f32_32x32x16_bf16 v[96:111], v[148:151], a[20:23], v[96:111]
    ds_read_b128 v[136:139], v2 offset:26624
    buffer_load_dwordx4 v2, s[32:35], s42 offen offset:2048 sc1 lds
    v_max_f32 v17, 0, v17
    v_max_f32 v18, 0, v18
    v_max_f32 v19, 0, v19
    v_mfma_f32_32x32x16_bf16 v[112:127], v[152:155], a[20:23], v[112:127]
    v_max_f32 v20, 0, v20
    v_max_f32 v21, 0, v21
    v_max_f32 v22, 0, v22
    s_waitcnt lgkmcnt(0)
    v_mfma_f32_32x32x16_bf16 v[80:95], v[128:131], a[24:27], v[80:95]
    ds_read_b128 v[144:147], v2 offset:28672
    ds_read_b128 v[148:151], v2 offset:29696
    v_max_f32 v23, 0, v23
    v_mul_f32 v16, v16, v24
    v_mul_f32 v17, v17, v25
    v_mul_f32 v18, v18, v26
    v_mfma_f32_32x32x16_bf16 v[96:111], v[132:135], a[24:27], v[96:111]
    ds_read_b128 v[152:155], v2 offset:30720
    v_mul_f32 v19, v19, v27
    v_mul_f32 v20, v20, v28
    v_mul_f32 v21, v21, v29
    v_mfma_f32_32x32x16_bf16 v[112:127], v[136:139], a[24:27], v[112:127]
    v_mul_f32 v22, v22, v30
    v_mul_f32 v23, v23, v31
    v_cvt_pk_bf16_f32 v192, v16, v17
    s_waitcnt lgkmcnt(0)
    s_waitcnt vmcnt(12)
    s_barrier
    v_mfma_f32_32x32x16_bf16 v[80:95], v[144:147], a[28:31], v[80:95]
    ds_read_b128 v[128:131], v2 offset:32768
    ds_read_b128 v[132:135], v2 offset:33792
    v_cvt_pk_bf16_f32 v193, v18, v19
    v_cvt_pk_bf16_f32 v194, v20, v21
    v_cvt_pk_bf16_f32 v195, v22, v23
    buffer_store_dwordx4 v[192:195], v2, s[32:35], s54 offen offset:0 sc1
    v_mfma_f32_32x32x16_bf16 v[96:111], v[148:151], a[28:31], v[96:111]
    ds_read_b128 v[136:139], v2 offset:34816
    ds_read_b128 v[160:163], v11 offset:256
    ds_read_b128 v[176:179], v11 offset:384
    ds_read_b128 v[164:167], v11 offset:288
    v_mfma_f32_32x32x16_bf16 v[112:127], v[152:155], a[28:31], v[112:127]
    ds_read_b128 v[180:183], v11 offset:416
    ds_read_b128 v[168:171], v11 offset:320
    ds_read_b128 v[184:187], v11 offset:448
    s_waitcnt lgkmcnt(6)
    v_mfma_f32_32x32x16_bf16 v[80:95], v[128:131], a[32:35], v[80:95]
    ds_read_b128 v[144:147], v2 offset:36864
    ds_read_b128 v[148:151], v2 offset:37888
    ds_read_b128 v[172:175], v11 offset:352
    ds_read_b128 v[188:191], v11 offset:480
    v_mfma_f32_32x32x16_bf16 v[96:111], v[132:135], a[32:35], v[96:111]
    ds_read_b128 v[152:155], v2 offset:38912
    s_add_u32 m0, s41, 114688
    s_add_u32 s42, s40, 204800
    buffer_load_dwordx4 v2, s[32:35], s42 offen offset:0 sc1 lds
    s_waitcnt lgkmcnt(1)
    v_fma_f32 v160, v202, v160, v176
    v_fma_f32 v161, v202, v161, v177
    v_mfma_f32_32x32x16_bf16 v[112:127], v[136:139], a[32:35], v[112:127]
    buffer_load_dwordx4 v2, s[32:35], s42 offen offset:1024 sc1 lds
    v_fma_f32 v162, v202, v162, v178
    v_fma_f32 v163, v202, v163, v179
    v_fma_f32 v164, v202, v164, v180
    s_waitcnt lgkmcnt(0)
    v_mfma_f32_32x32x16_bf16 v[80:95], v[144:147], a[36:39], v[80:95]
    ds_read_b128 v[128:131], v2 offset:40960
    ds_read_b128 v[132:135], v2 offset:41984
    v_fma_f32 v165, v202, v165, v181
    v_fma_f32 v166, v202, v166, v182
    v_fma_f32 v167, v202, v167, v183
    v_fma_f32 v168, v202, v168, v184
    v_mfma_f32_32x32x16_bf16 v[96:111], v[148:151], a[36:39], v[96:111]
    ds_read_b128 v[136:139], v2 offset:43008
    buffer_load_dwordx4 v2, s[32:35], s42 offen offset:2048 sc1 lds
    v_fma_f32 v169, v202, v169, v185
    v_fma_f32 v170, v202, v170, v186
    v_fma_f32 v171, v202, v171, v187
    v_mfma_f32_32x32x16_bf16 v[112:127], v[152:155], a[36:39], v[112:127]
    v_fma_f32 v172, v202, v172, v188
    v_fma_f32 v173, v202, v173, v189
    v_fma_f32 v174, v202, v174, v190
    s_waitcnt lgkmcnt(0)
    v_mfma_f32_32x32x16_bf16 v[80:95], v[128:131], a[40:43], v[80:95]
    ds_read_b128 v[144:147], v2 offset:45056
    ds_read_b128 v[148:151], v2 offset:46080
    v_fma_f32 v175, v202, v175, v191
    v_fma_f32 v32, v200, v32, v160
    v_fma_f32 v33, v200, v33, v161
    v_fma_f32 v34, v200, v34, v162
    v_mfma_f32_32x32x16_bf16 v[96:111], v[132:135], a[40:43], v[96:111]
    ds_read_b128 v[152:155], v2 offset:47104
    v_fma_f32 v35, v200, v35, v163
    v_fma_f32 v36, v200, v36, v164
    v_fma_f32 v37, v200, v37, v165
    v_mfma_f32_32x32x16_bf16 v[112:127], v[136:139], a[40:43], v[112:127]
    v_fma_f32 v38, v200, v38, v166
    v_fma_f32 v39, v200, v39, v167
    v_fma_f32 v40, v200, v40, v168
    s_waitcnt lgkmcnt(0)
    s_waitcnt vmcnt(13)
    s_barrier
    v_mfma_f32_32x32x16_bf16 v[80:95], v[144:147], a[44:47], v[80:95]
    ds_read_b128 v[128:131], v2 offset:49152
    ds_read_b128 v[132:135], v2 offset:50176
    v_fma_f32 v41, v200, v41, v169
    v_fma_f32 v42, v200, v42, v170
    v_fma_f32 v43, v200, v43, v171
    v_fma_f32 v44, v200, v44, v172
    v_mfma_f32_32x32x16_bf16 v[96:111], v[148:151], a[44:47], v[96:111]
    ds_read_b128 v[136:139], v2 offset:51200
    v_fma_f32 v45, v200, v45, v173
    v_fma_f32 v46, v200, v46, v174
    v_fma_f32 v47, v200, v47, v175
    v_mfma_f32_32x32x16_bf16 v[112:127], v[152:155], a[44:47], v[112:127]
    v_max_f32 v32, 0, v32
    v_max_f32 v33, 0, v33
    v_max_f32 v34, 0, v34
    s_waitcnt lgkmcnt(0)
    v_mfma_f32_32x32x16_bf16 v[80:95], v[128:131], a[48:51], v[80:95]
    ds_read_b128 v[144:147], v2 offset:53248
    ds_read_b128 v[148:151], v2 offset:54272
    v_max_f32 v35, 0, v35
    v_max_f32 v36, 0, v36
    v_max_f32 v37, 0, v37
    v_max_f32 v38, 0, v38
    v_mfma_f32_32x32x16_bf16 v[96:111], v[132:135], a[48:51], v[96:111]
    ds_read_b128 v[152:155], v2 offset:55296
    v_add_u32 v13, 384, v12
    v_min_u32 v13, 1834992, v13
    global_load_dwordx4 a[236:239], v13, s[18:19]
    v_max_f32 v39, 0, v39
    v_mul_f32 v32, v32, v40
    v_mul_f32 v33, v33, v41
    v_mfma_f32_32x32x16_bf16 v[112:127], v[136:139], a[48:51], v[112:127]
    v_add_u32 v13, 8576, v12
    v_min_u32 v13, 1834992, v13
    global_load_dwordx4 a[236:239], v13, s[18:19]
    v_mul_f32 v34, v34, v42
    v_mul_f32 v35, v35, v43
    v_mul_f32 v36, v36, v44
    s_waitcnt lgkmcnt(0)
    v_mfma_f32_32x32x16_bf16 v[80:95], v[144:147], a[52:55], v[80:95]
    ds_read_b128 v[128:131], v2 offset:57344
    ds_read_b128 v[132:135], v2 offset:58368
    v_mul_f32 v37, v37, v45
    v_mul_f32 v38, v38, v46
    v_mul_f32 v39, v39, v47
    v_cvt_pk_bf16_f32 v196, v32, v33
    v_mfma_f32_32x32x16_bf16 v[96:111], v[148:151], a[52:55], v[96:111]
    ds_read_b128 v[136:139], v2 offset:59392
    v_cvt_pk_bf16_f32 v197, v34, v35
    v_cvt_pk_bf16_f32 v198, v36, v37
    v_cvt_pk_bf16_f32 v199, v38, v39
    v_mfma_f32_32x32x16_bf16 v[112:127], v[152:155], a[52:55], v[112:127]
    buffer_store_dwordx4 v[196:199], v2, s[32:35], s54 offen offset:1024 sc1
    ds_read_b128 v[160:163], v11 offset:512
    ds_read_b128 v[176:179], v11 offset:640
    s_waitcnt lgkmcnt(2)
    v_mfma_f32_32x32x16_bf16 v[80:95], v[128:131], a[56:59], v[80:95]
    ds_read_b128 v[144:147], v2 offset:61440
    ds_read_b128 v[148:151], v2 offset:62464
    ds_read_b128 v[164:167], v11 offset:544
    ds_read_b128 v[180:183], v11 offset:672
    ds_read_b128 v[168:171], v11 offset:576
    ds_read_b128 v[184:187], v11 offset:704
    v_mfma_f32_32x32x16_bf16 v[96:111], v[132:135], a[56:59], v[96:111]
    ds_read_b128 v[152:155], v2 offset:63488
    ds_read_b128 v[172:175], v11 offset:608
    ds_read_b128 v[188:191], v11 offset:736
    v_mfma_f32_32x32x16_bf16 v[112:127], v[136:139], a[56:59], v[112:127]
    s_waitcnt lgkmcnt(0)
    v_fma_f32 v160, v202, v160, v176
    s_waitcnt vmcnt(13)
    s_barrier
    v_mfma_f32_32x32x16_bf16 v[80:95], v[144:147], a[60:63], v[80:95]
    ds_read_b128 v[128:131], v7 offset:0
    ds_read_b128 v[132:135], v7 offset:1024
    v_fma_f32 v161, v202, v161, v177
    v_fma_f32 v162, v202, v162, v178
    v_fma_f32 v163, v202, v163, v179
    v_fma_f32 v164, v202, v164, v180
    v_mfma_f32_32x32x16_bf16 v[96:111], v[148:151], a[60:63], v[96:111]
    ds_read_b128 v[136:139], v7 offset:2048
    v_fma_f32 v165, v202, v165, v181
    v_fma_f32 v166, v202, v166, v182
    v_fma_f32 v167, v202, v167, v183
    v_mfma_f32_32x32x16_bf16 v[112:127], v[152:155], a[60:63], v[112:127]
    v_fma_f32 v168, v202, v168, v184
    v_fma_f32 v169, v202, v169, v185
    v_fma_f32 v170, v202, v170, v186
    s_waitcnt lgkmcnt(0)
    v_mfma_f32_32x32x16_bf16 v[80:95], v[128:131], a[64:67], v[80:95]
    ds_read_b128 v[144:147], v7 offset:4096
    ds_read_b128 v[148:151], v7 offset:5120
    v_fma_f32 v171, v202, v171, v187
    v_fma_f32 v172, v202, v172, v188
    v_fma_f32 v173, v202, v173, v189
    v_fma_f32 v174, v202, v174, v190
    v_mfma_f32_32x32x16_bf16 v[96:111], v[132:135], a[64:67], v[96:111]
    ds_read_b128 v[152:155], v7 offset:6144
    v_fma_f32 v175, v202, v175, v191
    v_fma_f32 v48, v200, v48, v160
    v_fma_f32 v49, v200, v49, v161
    v_mfma_f32_32x32x16_bf16 v[112:127], v[136:139], a[64:67], v[112:127]
    v_fma_f32 v50, v200, v50, v162
    v_fma_f32 v51, v200, v51, v163
    v_fma_f32 v52, v200, v52, v164
    s_waitcnt lgkmcnt(0)
    v_mfma_f32_32x32x16_bf16 v[80:95], v[144:147], a[68:71], v[80:95]
    ds_read_b128 v[128:131], v7 offset:8192
    ds_read_b128 v[132:135], v7 offset:9216
    v_fma_f32 v53, v200, v53, v165
    v_fma_f32 v54, v200, v54, v166
    v_fma_f32 v55, v200, v55, v167
    v_fma_f32 v56, v200, v56, v168
    v_mfma_f32_32x32x16_bf16 v[96:111], v[148:151], a[68:71], v[96:111]
    ds_read_b128 v[136:139], v7 offset:10240
    v_fma_f32 v57, v200, v57, v169
    v_fma_f32 v58, v200, v58, v170
    v_fma_f32 v59, v200, v59, v171
    v_mfma_f32_32x32x16_bf16 v[112:127], v[152:155], a[68:71], v[112:127]
    v_fma_f32 v60, v200, v60, v172
    v_fma_f32 v61, v200, v61, v173
    v_fma_f32 v62, v200, v62, v174
    s_waitcnt lgkmcnt(0)
    v_mfma_f32_32x32x16_bf16 v[80:95], v[128:131], a[72:75], v[80:95]
    ds_read_b128 v[144:147], v7 offset:12288
    ds_read_b128 v[148:151], v7 offset:13312
    v_fma_f32 v63, v200, v63, v175
    v_max_f32 v48, 0, v48
    v_max_f32 v49, 0, v49
    v_max_f32 v50, 0, v50
    v_mfma_f32_32x32x16_bf16 v[96:111], v[132:135], a[72:75], v[96:111]
    ds_read_b128 v[152:155], v7 offset:14336
    v_max_f32 v51, 0, v51
    v_max_f32 v52, 0, v52
    v_max_f32 v53, 0, v53
    v_mfma_f32_32x32x16_bf16 v[112:127], v[136:139], a[72:75], v[112:127]
    v_max_f32 v54, 0, v54
    v_max_f32 v55, 0, v55
    v_mul_f32 v48, v48, v56
    s_waitcnt lgkmcnt(0)
    s_waitcnt vmcnt(10)
    s_barrier
    v_mfma_f32_32x32x16_bf16 v[80:95], v[144:147], a[76:79], v[80:95]
    ds_read_b128 v[128:131], v7 offset:16384
    ds_read_b128 v[132:135], v7 offset:17408
    v_mul_f32 v49, v49, v57
    v_mul_f32 v50, v50, v58
    v_mul_f32 v51, v51, v59
    v_mul_f32 v52, v52, v60
    v_mfma_f32_32x32x16_bf16 v[96:111], v[148:151], a[76:79], v[96:111]
    ds_read_b128 v[136:139], v7 offset:18432
    v_mul_f32 v53, v53, v61
    v_mul_f32 v54, v54, v62
    v_mul_f32 v55, v55, v63
    v_mfma_f32_32x32x16_bf16 v[112:127], v[152:155], a[76:79], v[112:127]
    v_cvt_pk_bf16_f32 v192, v48, v49
    v_cvt_pk_bf16_f32 v193, v50, v51
    v_cvt_pk_bf16_f32 v194, v52, v53
    s_waitcnt lgkmcnt(0)
    v_mfma_f32_32x32x16_bf16 v[80:95], v[128:131], a[80:83], v[80:95]
    ds_read_b128 v[144:147], v7 offset:20480
    ds_read_b128 v[148:151], v7 offset:21504
    v_cvt_pk_bf16_f32 v195, v54, v55
    buffer_store_dwordx4 v[192:195], v2, s[32:35], s54 offen offset:2048 sc1
    ds_read_b128 v[160:163], v11 offset:768
    ds_read_b128 v[176:179], v11 offset:896
    v_mfma_f32_32x32x16_bf16 v[96:111], v[132:135], a[80:83], v[96:111]
    ds_read_b128 v[152:155], v7 offset:22528
    ds_read_b128 v[164:167], v11 offset:800
    ds_read_b128 v[180:183], v11 offset:928
    ds_read_b128 v[168:171], v11 offset:832
    v_mfma_f32_32x32x16_bf16 v[112:127], v[136:139], a[80:83], v[112:127]
    ds_read_b128 v[184:187], v11 offset:960
    ds_read_b128 v[172:175], v11 offset:864
    ds_read_b128 v[188:191], v11 offset:992
    s_waitcnt lgkmcnt(6)
    v_mfma_f32_32x32x16_bf16 v[80:95], v[144:147], a[84:87], v[80:95]
    ds_read_b128 v[128:131], v7 offset:24576
    ds_read_b128 v[132:135], v7 offset:25600
    s_waitcnt lgkmcnt(2)
    v_fma_f32 v160, v202, v160, v176
    v_mfma_f32_32x32x16_bf16 v[96:111], v[148:151], a[84:87], v[96:111]
    ds_read_b128 v[136:139], v7 offset:26624
    v_fma_f32 v161, v202, v161, v177
    v_fma_f32 v162, v202, v162, v178
    v_fma_f32 v163, v202, v163, v179
    v_mfma_f32_32x32x16_bf16 v[112:127], v[152:155], a[84:87], v[112:127]
    v_fma_f32 v164, v202, v164, v180
    v_fma_f32 v165, v202, v165, v181
    v_fma_f32 v166, v202, v166, v182
    s_waitcnt lgkmcnt(0)
    v_mfma_f32_32x32x16_bf16 v[80:95], v[128:131], a[88:91], v[80:95]
    ds_read_b128 v[144:147], v7 offset:28672
    ds_read_b128 v[148:151], v7 offset:29696
    v_fma_f32 v167, v202, v167, v183
    v_fma_f32 v168, v202, v168, v184
    v_fma_f32 v169, v202, v169, v185
    v_fma_f32 v170, v202, v170, v186
    v_mfma_f32_32x32x16_bf16 v[96:111], v[132:135], a[88:91], v[96:111]
    ds_read_b128 v[152:155], v7 offset:30720
    v_fma_f32 v171, v202, v171, v187
    v_fma_f32 v172, v202, v172, v188
    v_fma_f32 v173, v202, v173, v189
    v_mfma_f32_32x32x16_bf16 v[112:127], v[136:139], a[88:91], v[112:127]
    v_fma_f32 v174, v202, v174, v190
    v_fma_f32 v175, v202, v175, v191
    v_fma_f32 v64, v200, v64, v160
    s_waitcnt lgkmcnt(0)
    s_waitcnt vmcnt(8)
    s_barrier
    v_mfma_f32_32x32x16_bf16 v[80:95], v[144:147], a[92:95], v[80:95]
    ds_read_b128 v[128:131], v7 offset:32768
    ds_read_b128 v[132:135], v7 offset:33792
    v_fma_f32 v65, v200, v65, v161
    v_fma_f32 v66, v200, v66, v162
    v_fma_f32 v67, v200, v67, v163
    v_fma_f32 v68, v200, v68, v164
    v_mfma_f32_32x32x16_bf16 v[96:111], v[148:151], a[92:95], v[96:111]
    ds_read_b128 v[136:139], v7 offset:34816
    v_fma_f32 v69, v200, v69, v165
    v_fma_f32 v70, v200, v70, v166
    v_fma_f32 v71, v200, v71, v167
    v_mfma_f32_32x32x16_bf16 v[112:127], v[152:155], a[92:95], v[112:127]
    v_fma_f32 v72, v200, v72, v168
    v_fma_f32 v73, v200, v73, v169
    v_fma_f32 v74, v200, v74, v170
    s_waitcnt lgkmcnt(0)
    v_mfma_f32_32x32x16_bf16 v[80:95], v[128:131], a[96:99], v[80:95]
    ds_read_b128 v[144:147], v7 offset:36864
    ds_read_b128 v[148:151], v7 offset:37888
    v_fma_f32 v75, v200, v75, v171
    v_fma_f32 v76, v200, v76, v172
    v_fma_f32 v77, v200, v77, v173
    v_fma_f32 v78, v200, v78, v174
    v_mfma_f32_32x32x16_bf16 v[96:111], v[132:135], a[96:99], v[96:111]
    ds_read_b128 v[152:155], v7 offset:38912
    v_fma_f32 v79, v200, v79, v175
    v_max_f32 v64, 0, v64
    v_max_f32 v65, 0, v65
    v_mfma_f32_32x32x16_bf16 v[112:127], v[136:139], a[96:99], v[112:127]
    v_max_f32 v66, 0, v66
    v_max_f32 v67, 0, v67
    v_max_f32 v68, 0, v68
    s_waitcnt lgkmcnt(0)
    v_mfma_f32_32x32x16_bf16 v[80:95], v[144:147], a[100:103], v[80:95]
    ds_read_b128 v[128:131], v7 offset:40960
    ds_read_b128 v[132:135], v7 offset:41984
    v_max_f32 v69, 0, v69
    v_max_f32 v70, 0, v70
    v_max_f32 v71, 0, v71
    v_mul_f32 v64, v64, v72
    v_mfma_f32_32x32x16_bf16 v[96:111], v[148:151], a[100:103], v[96:111]
    ds_read_b128 v[136:139], v7 offset:43008
    v_mul_f32 v65, v65, v73
    v_mul_f32 v66, v66, v74
    v_mul_f32 v67, v67, v75
    v_mfma_f32_32x32x16_bf16 v[112:127], v[152:155], a[100:103], v[112:127]
    v_mul_f32 v68, v68, v76
    v_mul_f32 v69, v69, v77
    v_mul_f32 v70, v70, v78
    s_waitcnt lgkmcnt(0)
    v_mfma_f32_32x32x16_bf16 v[80:95], v[128:131], a[104:107], v[80:95]
    ds_read_b128 v[144:147], v7 offset:45056
    ds_read_b128 v[148:151], v7 offset:46080
    v_mul_f32 v71, v71, v79
    v_cvt_pk_bf16_f32 v196, v64, v65
    v_cvt_pk_bf16_f32 v197, v66, v67
    v_cvt_pk_bf16_f32 v198, v68, v69
    v_mfma_f32_32x32x16_bf16 v[96:111], v[132:135], a[104:107], v[96:111]
    ds_read_b128 v[152:155], v7 offset:47104
    v_cvt_pk_bf16_f32 v199, v70, v71
    buffer_store_dwordx4 v[196:199], v2, s[32:35], s54 offen offset:3072 sc1
    v_mfma_f32_32x32x16_bf16 v[112:127], v[136:139], a[104:107], v[112:127]
    s_waitcnt lgkmcnt(0)
    s_waitcnt vmcnt(5)
    s_barrier
    v_mfma_f32_32x32x16_bf16 v[80:95], v[144:147], a[108:111], v[80:95]
    ds_read_b128 v[128:131], v7 offset:49152
    ds_read_b128 v[132:135], v7 offset:50176
    v_mfma_f32_32x32x16_bf16 v[96:111], v[148:151], a[108:111], v[96:111]
    ds_read_b128 v[136:139], v7 offset:51200
    v_mfma_f32_32x32x16_bf16 v[112:127], v[152:155], a[108:111], v[112:127]
    s_waitcnt lgkmcnt(0)
    v_mfma_f32_32x32x16_bf16 v[80:95], v[128:131], a[112:115], v[80:95]
    ds_read_b128 v[144:147], v7 offset:53248
    ds_read_b128 v[148:151], v7 offset:54272
    v_mfma_f32_32x32x16_bf16 v[96:111], v[132:135], a[112:115], v[96:111]
    ds_read_b128 v[152:155], v7 offset:55296
    v_mfma_f32_32x32x16_bf16 v[112:127], v[136:139], a[112:115], v[112:127]
    s_waitcnt lgkmcnt(0)
    v_mfma_f32_32x32x16_bf16 v[80:95], v[144:147], a[116:119], v[80:95]
    ds_read_b128 v[128:131], v7 offset:57344
    ds_read_b128 v[132:135], v7 offset:58368
    v_mfma_f32_32x32x16_bf16 v[96:111], v[148:151], a[116:119], v[96:111]
    ds_read_b128 v[136:139], v7 offset:59392
    v_mfma_f32_32x32x16_bf16 v[112:127], v[152:155], a[116:119], v[112:127]
    s_waitcnt lgkmcnt(0)
    v_mfma_f32_32x32x16_bf16 v[80:95], v[128:131], a[120:123], v[80:95]
    ds_read_b128 v[144:147], v7 offset:61440
    ds_read_b128 v[148:151], v7 offset:62464
    v_mfma_f32_32x32x16_bf16 v[96:111], v[132:135], a[120:123], v[96:111]
    ds_read_b128 v[152:155], v7 offset:63488
    v_mfma_f32_32x32x16_bf16 v[112:127], v[136:139], a[120:123], v[112:127]
    s_waitcnt lgkmcnt(0)
    v_mfma_f32_32x32x16_bf16 v[80:95], v[144:147], a[124:127], v[80:95]
    v_mfma_f32_32x32x16_bf16 v[96:111], v[148:151], a[124:127], v[96:111]
    v_mfma_f32_32x32x16_bf16 v[112:127], v[152:155], a[124:127], v[112:127]
    ds_read_b128 v[160:163], v11 offset:1024
    ds_read_b128 v[176:179], v11 offset:1152
    ds_read_b128 v[164:167], v11 offset:1056
    ds_read_b128 v[180:183], v11 offset:1184
    ds_read_b128 v[168:171], v11 offset:1088
    ds_read_b128 v[184:187], v11 offset:1216
    ds_read_b128 v[172:175], v11 offset:1120
    ds_read_b128 v[188:191], v11 offset:1248
    s_waitcnt lgkmcnt(0)
    v_pk_fma_f32 v[160:161], v[202:203], v[160:161], v[176:177] op_sel_hi:[0,1,1]
    v_pk_fma_f32 v[162:163], v[202:203], v[162:163], v[178:179] op_sel_hi:[0,1,1]
    v_pk_fma_f32 v[164:165], v[202:203], v[164:165], v[180:181] op_sel_hi:[0,1,1]
    v_pk_fma_f32 v[166:167], v[202:203], v[166:167], v[182:183] op_sel_hi:[0,1,1]
    v_pk_fma_f32 v[168:169], v[202:203], v[168:169], v[184:185] op_sel_hi:[0,1,1]
    v_pk_fma_f32 v[170:171], v[202:203], v[170:171], v[186:187] op_sel_hi:[0,1,1]
    v_pk_fma_f32 v[172:173], v[202:203], v[172:173], v[188:189] op_sel_hi:[0,1,1]
    v_pk_fma_f32 v[174:175], v[202:203], v[174:175], v[190:191] op_sel_hi:[0,1,1]
    v_pk_fma_f32 v[80:81], v[200:201], v[80:81], v[160:161] op_sel_hi:[0,1,1]
    v_pk_fma_f32 v[82:83], v[200:201], v[82:83], v[162:163] op_sel_hi:[0,1,1]
    v_pk_fma_f32 v[84:85], v[200:201], v[84:85], v[164:165] op_sel_hi:[0,1,1]
    v_pk_fma_f32 v[86:87], v[200:201], v[86:87], v[166:167] op_sel_hi:[0,1,1]
    v_pk_fma_f32 v[88:89], v[200:201], v[88:89], v[168:169] op_sel_hi:[0,1,1]
    v_pk_fma_f32 v[90:91], v[200:201], v[90:91], v[170:171] op_sel_hi:[0,1,1]
    v_pk_fma_f32 v[92:93], v[200:201], v[92:93], v[172:173] op_sel_hi:[0,1,1]
    v_pk_fma_f32 v[94:95], v[200:201], v[94:95], v[174:175] op_sel_hi:[0,1,1]
    v_max_f32 v80, 0, v80
    v_max_f32 v81, 0, v81
    v_max_f32 v82, 0, v82
    v_max_f32 v83, 0, v83
    v_max_f32 v84, 0, v84
    v_max_f32 v85, 0, v85
    v_max_f32 v86, 0, v86
    v_max_f32 v87, 0, v87
    v_pk_mul_f32 v[80:81], v[80:81], v[88:89]
    v_pk_mul_f32 v[82:83], v[82:83], v[90:91]
    v_pk_mul_f32 v[84:85], v[84:85], v[92:93]
    v_pk_mul_f32 v[86:87], v[86:87], v[94:95]
    v_cvt_pk_bf16_f32 v192, v80, v81
    v_cvt_pk_bf16_f32 v193, v82, v83
    v_cvt_pk_bf16_f32 v194, v84, v85
    v_cvt_pk_bf16_f32 v195, v86, v87
    buffer_store_dwordx4 v[192:195], v2, s[32:35], s55 offen offset:0 sc1
    ds_read_b128 v[160:163], v11 offset:1280
    ds_read_b128 v[176:179], v11 offset:1408
    ds_read_b128 v[164:167], v11 offset:1312
    ds_read_b128 v[180:183], v11 offset:1440
    ds_read_b128 v[168:171], v11 offset:1344
    ds_read_b128 v[184:187], v11 offset:1472
    ds_read_b128 v[172:175], v11 offset:1376
    ds_read_b128 v[188:191], v11 offset:1504
    s_waitcnt lgkmcnt(0)
    v_pk_fma_f32 v[160:161], v[202:203], v[160:161], v[176:177] op_sel_hi:[0,1,1]
    v_pk_fma_f32 v[162:163], v[202:203], v[162:163], v[178:179] op_sel_hi:[0,1,1]
    v_pk_fma_f32 v[164:165], v[202:203], v[164:165], v[180:181] op_sel_hi:[0,1,1]
    v_pk_fma_f32 v[166:167], v[202:203], v[166:167], v[182:183] op_sel_hi:[0,1,1]
    v_pk_fma_f32 v[168:169], v[202:203], v[168:169], v[184:185] op_sel_hi:[0,1,1]
    v_pk_fma_f32 v[170:171], v[202:203], v[170:171], v[186:187] op_sel_hi:[0,1,1]
    v_pk_fma_f32 v[172:173], v[202:203], v[172:173], v[188:189] op_sel_hi:[0,1,1]
    v_pk_fma_f32 v[174:175], v[202:203], v[174:175], v[190:191] op_sel_hi:[0,1,1]
    v_pk_fma_f32 v[96:97], v[200:201], v[96:97], v[160:161] op_sel_hi:[0,1,1]
    v_pk_fma_f32 v[98:99], v[200:201], v[98:99], v[162:163] op_sel_hi:[0,1,1]
    v_pk_fma_f32 v[100:101], v[200:201], v[100:101], v[164:165] op_sel_hi:[0,1,1]
    v_pk_fma_f32 v[102:103], v[200:201], v[102:103], v[166:167] op_sel_hi:[0,1,1]
    v_pk_fma_f32 v[104:105], v[200:201], v[104:105], v[168:169] op_sel_hi:[0,1,1]
    v_pk_fma_f32 v[106:107], v[200:201], v[106:107], v[170:171] op_sel_hi:[0,1,1]
    v_pk_fma_f32 v[108:109], v[200:201], v[108:109], v[172:173] op_sel_hi:[0,1,1]
    v_pk_fma_f32 v[110:111], v[200:201], v[110:111], v[174:175] op_sel_hi:[0,1,1]
    v_max_f32 v96, 0, v96
    v_max_f32 v97, 0, v97
    v_max_f32 v98, 0, v98
    v_max_f32 v99, 0, v99
    v_max_f32 v100, 0, v100
    v_max_f32 v101, 0, v101
    v_max_f32 v102, 0, v102
    v_max_f32 v103, 0, v103
    v_pk_mul_f32 v[96:97], v[96:97], v[104:105]
    v_pk_mul_f32 v[98:99], v[98:99], v[106:107]
    v_pk_mul_f32 v[100:101], v[100:101], v[108:109]
    v_pk_mul_f32 v[102:103], v[102:103], v[110:111]
    v_cvt_pk_bf16_f32 v196, v96, v97
    v_cvt_pk_bf16_f32 v197, v98, v99
    v_cvt_pk_bf16_f32 v198, v100, v101
    v_cvt_pk_bf16_f32 v199, v102, v103
    buffer_store_dwordx4 v[196:199], v2, s[32:35], s55 offen offset:1024 sc1
    ds_read_b128 v[160:163], v11 offset:1536
    ds_read_b128 v[176:179], v11 offset:1664
    ds_read_b128 v[164:167], v11 offset:1568
    ds_read_b128 v[180:183], v11 offset:1696
    ds_read_b128 v[168:171], v11 offset:1600
    ds_read_b128 v[184:187], v11 offset:1728
    ds_read_b128 v[172:175], v11 offset:1632
    ds_read_b128 v[188:191], v11 offset:1760
    s_waitcnt lgkmcnt(0)
    v_pk_fma_f32 v[160:161], v[202:203], v[160:161], v[176:177] op_sel_hi:[0,1,1]
    v_pk_fma_f32 v[162:163], v[202:203], v[162:163], v[178:179] op_sel_hi:[0,1,1]
    v_pk_fma_f32 v[164:165], v[202:203], v[164:165], v[180:181] op_sel_hi:[0,1,1]
    v_pk_fma_f32 v[166:167], v[202:203], v[166:167], v[182:183] op_sel_hi:[0,1,1]
    v_pk_fma_f32 v[168:169], v[202:203], v[168:169], v[184:185] op_sel_hi:[0,1,1]
    v_pk_fma_f32 v[170:171], v[202:203], v[170:171], v[186:187] op_sel_hi:[0,1,1]
    v_pk_fma_f32 v[172:173], v[202:203], v[172:173], v[188:189] op_sel_hi:[0,1,1]
    v_pk_fma_f32 v[174:175], v[202:203], v[174:175], v[190:191] op_sel_hi:[0,1,1]
    v_pk_fma_f32 v[112:113], v[200:201], v[112:113], v[160:161] op_sel_hi:[0,1,1]
    v_pk_fma_f32 v[114:115], v[200:201], v[114:115], v[162:163] op_sel_hi:[0,1,1]
    v_pk_fma_f32 v[116:117], v[200:201], v[116:117], v[164:165] op_sel_hi:[0,1,1]
    v_pk_fma_f32 v[118:119], v[200:201], v[118:119], v[166:167] op_sel_hi:[0,1,1]
    v_pk_fma_f32 v[120:121], v[200:201], v[120:121], v[168:169] op_sel_hi:[0,1,1]
    v_pk_fma_f32 v[122:123], v[200:201], v[122:123], v[170:171] op_sel_hi:[0,1,1]
    v_pk_fma_f32 v[124:125], v[200:201], v[124:125], v[172:173] op_sel_hi:[0,1,1]
    v_pk_fma_f32 v[126:127], v[200:201], v[126:127], v[174:175] op_sel_hi:[0,1,1]
    v_max_f32 v112, 0, v112
    v_max_f32 v113, 0, v113
    v_max_f32 v114, 0, v114
    v_max_f32 v115, 0, v115
    v_max_f32 v116, 0, v116
    v_max_f32 v117, 0, v117
    v_max_f32 v118, 0, v118
    v_max_f32 v119, 0, v119
    v_pk_mul_f32 v[112:113], v[112:113], v[120:121]
    v_pk_mul_f32 v[114:115], v[114:115], v[122:123]
    v_pk_mul_f32 v[116:117], v[116:117], v[124:125]
    v_pk_mul_f32 v[118:119], v[118:119], v[126:127]
    v_cvt_pk_bf16_f32 v192, v112, v113
    v_cvt_pk_bf16_f32 v193, v114, v115
    v_cvt_pk_bf16_f32 v194, v116, v117
    v_cvt_pk_bf16_f32 v195, v118, v119
    buffer_store_dwordx4 v[192:195], v2, s[32:35], s55 offen offset:2048 sc1
    s_waitcnt vmcnt(0)
    s_barrier
    s_cmp_lg_u32 s30, 0
    s_cbranch_scc1 s3a_skip
    s_lshl_b32 s60, s44, 8
    s_add_u32 s60, s60, 3993600
    v_mov_b32 v10, 0
    v_mov_b32 v11, 1
    s_mov_b64 exec, 1
    buffer_atomic_add v11, v10, s[32:35], s60 offen
    s_mov_b64 exec, -1
s3a_skip:
    s_and_b32 s46, s2, 7
    s_lshr_b32 s47, s2, 3
    s_lshl_b32 s44, s46, 2
    s_lshr_b32 s45, s47, 3
    s_add_u32 s44, s44, s45
    s_and_b32 s45, s47, 7
    s_mov_b32 s36, s18
    s_and_b32 s37, s19, 0xffff
    s_mov_b32 s38, 1835008
    s_mov_b32 s39, 0x20000
    v_lshrrev_b32 v3, 3, v1
    v_and_b32 v4, 7, v1
    v_bfe_u32 v5, v3, 1, 1
    v_lshlrev_b32 v5, 2, v5
    v_xor_b32 v4, v4, v5
    v_mul_u32_u24 v3, 1024, v3
    v_lshl_add_u32 v3, v4, 4, v3
    v_bfe_u32 v5, v1, 2, 2
    v_lshrrev_b32 v6, 5, v1
    v_lshl_add_u32 v4, v6, 2, v5
    v_lshlrev_b32 v4, 7, v4
    v_lshrrev_b32 v5, 1, v5
    v_lshlrev_b32 v5, 2, v5
    v_bfe_u32 v6, v1, 4, 1
    v_lshlrev_b32 v6, 1, v6
    v_xor_b32 v5, v5, v6
    v_bfe_u32 v6, v1, 1, 1
    v_xor_b32 v5, v5, v6
    v_lshl_add_u32 v4, v5, 4, v4
    v_and_b32 v6, 1, v1
    v_lshl_add_u32 v4, v6, 3, v4
    s_mul_i32 s40, s30, 28672
    v_add_u32 v4, s40, v4
    v_xor_b32 v5, 64, v4
    s_mul_i32 s41, s30, 458752
    s_lshl_b32 s42, s45, 7
    s_add_u32 s41, s41, s42
    s_add_u32 m0, s40, 0
    s_add_u32 s46, s41, 0
    buffer_load_dwordx4 v3, s[36:39], s46 offen lds
    s_add_u32 m0, s40, 1024
    s_add_u32 s46, s41, 8192
    buffer_load_dwordx4 v3, s[36:39], s46 offen lds
    s_add_u32 m0, s40, 2048
    s_add_u32 s46, s41, 16384
    buffer_load_dwordx4 v3, s[36:39], s46 offen lds
    s_add_u32 m0, s40, 3072
    s_add_u32 s46, s41, 24576
    buffer_load_dwordx4 v3, s[36:39], s46 offen lds
    s_add_u32 m0, s40, 4096
    s_add_u32 s46, s41, 32768
    buffer_load_dwordx4 v3, s[36:39], s46 offen lds
    s_add_u32 m0, s40, 5120
    s_add_u32 s46, s41, 40960
    buffer_load_dwordx4 v3, s[36:39], s46 offen lds
    s_add_u32 m0, s40, 6144
    s_add_u32 s46, s41, 49152
    buffer_load_dwordx4 v3, s[36:39], s46 offen lds
    s_add_u32 m0, s40, 7168
    s_add_u32 s46, s41, 57344
    buffer_load_dwordx4 v3, s[36:39], s46 offen lds
    s_add_u32 m0, s40, 8192
    s_add_u32 s46, s41, 65536
    buffer_load_dwordx4 v3, s[36:39], s46 offen lds
    s_add_u32 m0, s40, 9216
    s_add_u32 s46, s41, 73728
    buffer_load_dwordx4 v3, s[36:39], s46 offen lds
    s_add_u32 m0, s40, 10240
    s_add_u32 s46, s41, 81920
    buffer_load_dwordx4 v3, s[36:39], s46 offen lds
    s_add_u32 m0, s40, 11264
    s_add_u32 s46, s41, 90112
    buffer_load_dwordx4 v3, s[36:39], s46 offen lds
    s_add_u32 m0, s40, 12288
    s_add_u32 s46, s41, 98304
    buffer_load_dwordx4 v3, s[36:39], s46 offen lds
    s_add_u32 m0, s40, 13312
    s_add_u32 s46, s41, 106496
    buffer_load_dwordx4 v3, s[36:39], s46 offen lds
    s_lshr_b32 s58, s44, 1
    s_cmp_lg_u32 s30, 0
    s_cbranch_scc1 s3w_w
    s_lshl_b32 s60, s58, 8
    s_add_u32 s60, s60, 3993600
    v_mov_b32 v10, 0
    s_mov_b32 s61, 0
s3w_poll:
    buffer_load_dword v11, v10, s[32:35], s60 offen sc1
    s_waitcnt vmcnt(0)
    v_readfirstlane_b32 s62, v11
    s_add_u32 s61, s61, 1
    s_nop 2
    s_cmp_eq_u32 s62, 16
    s_cbranch_scc1 s3w_done
    s_cmp_lt_u32 s61, 400000
    s_cbranch_scc1 s3w_poll
s3w_done:
s3w_w:
    s_barrier
    s_mov_b32 s48, s24
    s_and_b32 s49, s25, 0xffff
    s_mov_b32 s50, 2097152
    s_mov_b32 s51, 0x20000
    s_mul_i32 s42, s44, 229376
    s_mul_i32 s43, s30, 28672
    s_add_u32 s42, s42, s43
    s_add_u32 s42, s42, 17825792
    s_add_u32 s43, s42, 114688
    s_add_u32 s47, s42, 0
    buffer_load_dwordx4 a[0:3], v2, s[32:35], s47 offen sc1
    s_add_u32 s47, s43, 0
    buffer_load_dwordx4 a[4:7], v2, s[32:35], s47 offen sc1
    s_add_u32 s47, s42, 1024
    buffer_load_dwordx4 a[8:11], v2, s[32:35], s47 offen sc1
    s_add_u32 s47, s43, 1024
    buffer_load_dwordx4 a[12:15], v2, s[32:35], s47 offen sc1
    s_add_u32 s47, s42, 2048
    buffer_load_dwordx4 a[16:19], v2, s[32:35], s47 offen sc1
    s_add_u32 s47, s43, 2048
    buffer_load_dwordx4 a[20:23], v2, s[32:35], s47 offen sc1
    s_add_u32 s47, s42, 3072
    buffer_load_dwordx4 a[24:27], v2, s[32:35], s47 offen sc1
    s_add_u32 s47, s43, 3072
    buffer_load_dwordx4 a[28:31], v2, s[32:35], s47 offen sc1
    s_add_u32 s47, s42, 4096
    buffer_load_dwordx4 a[32:35], v2, s[32:35], s47 offen sc1
    s_add_u32 s47, s43, 4096
    buffer_load_dwordx4 a[36:39], v2, s[32:35], s47 offen sc1
    s_add_u32 s47, s42, 5120
    buffer_load_dwordx4 a[40:43], v2, s[32:35], s47 offen sc1
    s_add_u32 s47, s43, 5120
    buffer_load_dwordx4 a[44:47], v2, s[32:35], s47 offen sc1
    s_add_u32 s47, s42, 6144
    buffer_load_dwordx4 a[48:51], v2, s[32:35], s47 offen sc1
    s_add_u32 s47, s43, 6144
    buffer_load_dwordx4 a[52:55], v2, s[32:35], s47 offen sc1
    v_and_b32 v8, 31, v1
    v_lshlrev_b32 v8, 10, v8
    v_lshrrev_b32 v6, 5, v1
    v_lshl_add_u32 v8, v6, 4, v8
    s_lshl_b32 s55, s30, 5
    v_add_u32 v8, s55, v8
    v_lshlrev_b32 v9, 5, v6
    s_lshl_b32 s55, s30, 6
    v_add_u32 v9, s55, v9
    s_lshl_b32 s52, s45, 8
    s_add_u32 s52, s52, 3680256
    s_waitcnt vmcnt(12)
    ds_read_b64_tr_b16 v[16:17], v4 offset:0
    ds_read_b64_tr_b16 v[18:19], v4 offset:1024
    ds_read_b64_tr_b16 v[20:21], v5 offset:0
    ds_read_b64_tr_b16 v[22:23], v5 offset:1024
    s_waitcnt lgkmcnt(0)
    s_waitcnt vmcnt(10)
    ds_read_b64_tr_b16 v[24:25], v4 offset:2048
    ds_read_b64_tr_b16 v[26:27], v4 offset:3072
    ds_read_b64_tr_b16 v[28:29], v5 offset:2048
    ds_read_b64_tr_b16 v[30:31], v5 offset:3072
    v_mfma_f32_32x32x16_bf16 v[48:63], v[16:19], a[0:3], 0
    s_add_u32 s47, s42, 7168
    buffer_load_dwordx4 a[56:59], v2, s[32:35], s47 offen sc1
    v_mfma_f32_32x32x16_bf16 v[64:79], v[20:23], a[0:3], 0
    s_add_u32 s47, s43, 7168
    buffer_load_dwordx4 a[60:63], v2, s[32:35], s47 offen sc1
    v_mfma_f32_32x32x16_bf16 v[80:95], v[16:19], a[4:7], 0
    s_add_u32 m0, s40, 14336
    s_add_u32 s46, s41, 114688
    buffer_load_dwordx4 v3, s[36:39], s46 offen lds
    v_mfma_f32_32x32x16_bf16 v[96:111], v[20:23], a[4:7], 0
    s_add_u32 m0, s40, 15360
    s_add_u32 s46, s41, 122880
    buffer_load_dwordx4 v3, s[36:39], s46 offen lds
    s_waitcnt lgkmcnt(0)
    s_waitcnt vmcnt(12)
    ds_read_b64_tr_b16 v[16:17], v4 offset:4096
    ds_read_b64_tr_b16 v[18:19], v4 offset:5120
    ds_read_b64_tr_b16 v[20:21], v5 offset:4096
    ds_read_b64_tr_b16 v[22:23], v5 offset:5120
    v_mfma_f32_32x32x16_bf16 v[48:63], v[24:27], a[8:11], v[48:63]
    s_add_u32 s47, s42, 8192
    buffer_load_dwordx4 a[64:67], v2, s[32:35], s47 offen sc1
    v_mfma_f32_32x32x16_bf16 v[64:79], v[28:31], a[8:11], v[64:79]
    s_add_u32 s47, s43, 8192
    buffer_load_dwordx4 a[68:71], v2, s[32:35], s47 offen sc1
    v_mfma_f32_32x32x16_bf16 v[80:95], v[24:27], a[12:15], v[80:95]
    s_add_u32 m0, s40, 16384
    s_add_u32 s46, s41, 131072
    buffer_load_dwordx4 v3, s[36:39], s46 offen lds
    v_mfma_f32_32x32x16_bf16 v[96:111], v[28:31], a[12:15], v[96:111]
    s_add_u32 m0, s40, 17408
    s_add_u32 s46, s41, 139264
    buffer_load_dwordx4 v3, s[36:39], s46 offen lds
    s_waitcnt lgkmcnt(0)
    s_waitcnt vmcnt(14)
    ds_read_b64_tr_b16 v[24:25], v4 offset:6144
    ds_read_b64_tr_b16 v[26:27], v4 offset:7168
    ds_read_b64_tr_b16 v[28:29], v5 offset:6144
    ds_read_b64_tr_b16 v[30:31], v5 offset:7168
    v_mfma_f32_32x32x16_bf16 v[48:63], v[16:19], a[16:19], v[48:63]
    s_add_u32 s47, s42, 9216
    buffer_load_dwordx4 a[72:75], v2, s[32:35], s47 offen sc1
    v_mfma_f32_32x32x16_bf16 v[64:79], v[20:23], a[16:19], v[64:79]
    s_add_u32 s47, s43, 9216
    buffer_load_dwordx4 a[76:79], v2, s[32:35], s47 offen sc1
    v_mfma_f32_32x32x16_bf16 v[80:95], v[16:19], a[20:23], v[80:95]
    s_add_u32 m0, s40, 18432
    s_add_u32 s46, s41, 147456
    buffer_load_dwordx4 v3, s[36:39], s46 offen lds
    v_mfma_f32_32x32x16_bf16 v[96:111], v[20:23], a[20:23], v[96:111]
    s_add_u32 m0, s40, 19456
    s_add_u32 s46, s41, 155648
    buffer_load_dwordx4 v3, s[36:39], s46 offen lds
    s_waitcnt lgkmcnt(0)
    s_waitcnt vmcnt(16)
    ds_read_b64_tr_b16 v[16:17], v4 offset:8192
    ds_read_b64_tr_b16 v[18:19], v4 offset:9216
    ds_read_b64_tr_b16 v[20:21], v5 offset:8192
    ds_read_b64_tr_b16 v[22:23], v5 offset:9216
    v_mfma_f32_32x32x16_bf16 v[48:63], v[24:27], a[24:27], v[48:63]
    s_add_u32 s47, s42, 10240
    buffer_load_dwordx4 a[80:83], v2, s[32:35], s47 offen sc1
    v_mfma_f32_32x32x16_bf16 v[64:79], v[28:31], a[24:27], v[64:79]
    s_add_u32 s47, s43, 10240
    buffer_load_dwordx4 a[84:87], v2, s[32:35], s47 offen sc1
    v_mfma_f32_32x32x16_bf16 v[80:95], v[24:27], a[28:31], v[80:95]
    s_add_u32 m0, s40, 20480
    s_add_u32 s46, s41, 163840
    buffer_load_dwordx4 v3, s[36:39], s46 offen lds
    v_mfma_f32_32x32x16_bf16 v[96:111], v[28:31], a[28:31], v[96:111]
    s_add_u32 m0, s40, 21504
    s_add_u32 s46, s41, 172032
    buffer_load_dwordx4 v3, s[36:39], s46 offen lds
    s_waitcnt lgkmcnt(0)
    s_waitcnt vmcnt(18)
    ds_read_b64_tr_b16 v[24:25], v4 offset:10240
    ds_read_b64_tr_b16 v[26:27], v4 offset:11264
    ds_read_b64_tr_b16 v[28:29], v5 offset:10240
    ds_read_b64_tr_b16 v[30:31], v5 offset:11264
    v_mfma_f32_32x32x16_bf16 v[48:63], v[16:19], a[32:35], v[48:63]
    s_add_u32 s47, s42, 11264
    buffer_load_dwordx4 a[88:91], v2, s[32:35], s47 offen sc1
    v_mfma_f32_32x32x16_bf16 v[64:79], v[20:23], a[32:35], v[64:79]
    s_add_u32 s47, s43, 11264
    buffer_load_dwordx4 a[92:95], v2, s[32:35], s47 offen sc1
    v_mfma_f32_32x32x16_bf16 v[80:95], v[16:19], a[36:39], v[80:95]
    s_add_u32 m0, s40, 22528
    s_add_u32 s46, s41, 180224
    buffer_load_dwordx4 v3, s[36:39], s46 offen lds
    v_mfma_f32_32x32x16_bf16 v[96:111], v[20:23], a[36:39], v[96:111]
    s_add_u32 m0, s40, 23552
    s_add_u32 s46, s41, 188416
    buffer_load_dwordx4 v3, s[36:39], s46 offen lds
    s_waitcnt lgkmcnt(0)
    s_waitcnt vmcnt(20)
    ds_read_b64_tr_b16 v[16:17], v4 offset:12288
    ds_read_b64_tr_b16 v[18:19], v4 offset:13312
    ds_read_b64_tr_b16 v[20:21], v5 offset:12288
    ds_read_b64_tr_b16 v[22:23], v5 offset:13312
    v_mfma_f32_32x32x16_bf16 v[48:63], v[24:27], a[40:43], v[48:63]
    s_add_u32 s47, s42, 12288
    buffer_load_dwordx4 a[96:99], v2, s[32:35], s47 offen sc1
    v_mfma_f32_32x32x16_bf16 v[64:79], v[28:31], a[40:43], v[64:79]
    s_add_u32 s47, s43, 12288
    buffer_load_dwordx4 a[100:103], v2, s[32:35], s47 offen sc1
    v_mfma_f32_32x32x16_bf16 v[80:95], v[24:27], a[44:47], v[80:95]
    s_add_u32 m0, s40, 24576
    s_add_u32 s46, s41, 196608
    buffer_load_dwordx4 v3, s[36:39], s46 offen lds
    v_mfma_f32_32x32x16_bf16 v[96:111], v[28:31], a[44:47], v[96:111]
    s_add_u32 m0, s40, 25600
    s_add_u32 s46, s41, 204800
    buffer_load_dwordx4 v3, s[36:39], s46 offen lds
    s_waitcnt lgkmcnt(0)
    s_waitcnt vmcnt(20)
    ds_read_b64_tr_b16 v[24:25], v4 offset:14336
    ds_read_b64_tr_b16 v[26:27], v4 offset:15360
    ds_read_b64_tr_b16 v[28:29], v5 offset:14336
    ds_read_b64_tr_b16 v[30:31], v5 offset:15360
    v_mfma_f32_32x32x16_bf16 v[48:63], v[16:19], a[48:51], v[48:63]
    s_add_u32 s47, s42, 13312
    buffer_load_dwordx4 a[104:107], v2, s[32:35], s47 offen sc1
    v_mfma_f32_32x32x16_bf16 v[64:79], v[20:23], a[48:51], v[64:79]
    s_add_u32 s47, s43, 13312
    buffer_load_dwordx4 a[108:111], v2, s[32:35], s47 offen sc1
    v_mfma_f32_32x32x16_bf16 v[80:95], v[16:19], a[52:55], v[80:95]
    s_add_u32 m0, s40, 26624
    s_add_u32 s46, s41, 212992
    buffer_load_dwordx4 v3, s[36:39], s46 offen lds
    v_mfma_f32_32x32x16_bf16 v[96:111], v[20:23], a[52:55], v[96:111]
    s_add_u32 m0, s40, 27648
    s_add_u32 s46, s41, 221184
    buffer_load_dwordx4 v3, s[36:39], s46 offen lds
    s_waitcnt lgkmcnt(0)
    s_waitcnt vmcnt(20)
    ds_read_b64_tr_b16 v[16:17], v4 offset:16384
    ds_read_b64_tr_b16 v[18:19], v4 offset:17408
    ds_read_b64_tr_b16 v[20:21], v5 offset:16384
    ds_read_b64_tr_b16 v[22:23], v5 offset:17408
    v_mfma_f32_32x32x16_bf16 v[48:63], v[24:27], a[56:59], v[48:63]
    s_add_u32 s47, s42, 14336
    buffer_load_dwordx4 a[0:3], v2, s[32:35], s47 offen sc1
    v_mfma_f32_32x32x16_bf16 v[64:79], v[28:31], a[56:59], v[64:79]
    s_add_u32 s47, s43, 14336
    buffer_load_dwordx4 a[4:7], v2, s[32:35], s47 offen sc1
    v_mfma_f32_32x32x16_bf16 v[80:95], v[24:27], a[60:63], v[80:95]
    s_add_u32 m0, s40, 0
    s_add_u32 s46, s41, 229376
    buffer_load_dwordx4 v3, s[36:39], s46 offen lds
    v_mfma_f32_32x32x16_bf16 v[96:111], v[28:31], a[60:63], v[96:111]
    s_add_u32 m0, s40, 1024
    s_add_u32 s46, s41, 237568
    buffer_load_dwordx4 v3, s[36:39], s46 offen lds
    s_waitcnt lgkmcnt(0)
    s_waitcnt vmcnt(20)
    ds_read_b64_tr_b16 v[24:25], v4 offset:18432
    ds_read_b64_tr_b16 v[26:27], v4 offset:19456
    ds_read_b64_tr_b16 v[28:29], v5 offset:18432
    ds_read_b64_tr_b16 v[30:31], v5 offset:19456
    v_mfma_f32_32x32x16_bf16 v[48:63], v[16:19], a[64:67], v[48:63]
    s_add_u32 s47, s42, 15360
    buffer_load_dwordx4 a[8:11], v2, s[32:35], s47 offen sc1
    v_mfma_f32_32x32x16_bf16 v[64:79], v[20:23], a[64:67], v[64:79]
    s_add_u32 s47, s43, 15360
    buffer_load_dwordx4 a[12:15], v2, s[32:35], s47 offen sc1
    v_mfma_f32_32x32x16_bf16 v[80:95], v[16:19], a[68:71], v[80:95]
    s_add_u32 m0, s40, 2048
    s_add_u32 s46, s41, 245760
    buffer_load_dwordx4 v3, s[36:39], s46 offen lds
    v_mfma_f32_32x32x16_bf16 v[96:111], v[20:23], a[68:71], v[96:111]
    s_add_u32 m0, s40, 3072
    s_add_u32 s46, s41, 253952
    buffer_load_dwordx4 v3, s[36:39], s46 offen lds
    s_waitcnt lgkmcnt(0)
    s_waitcnt vmcnt(20)
    ds_read_b64_tr_b16 v[16:17], v4 offset:20480
    ds_read_b64_tr_b16 v[18:19], v4 offset:21504
    ds_read_b64_tr_b16 v[20:21], v5 offset:20480
    ds_read_b64_tr_b16 v[22:23], v5 offset:21504
    v_mfma_f32_32x32x16_bf16 v[48:63], v[24:27], a[72:75], v[48:63]
    s_add_u32 s47, s42, 16384
    buffer_load_dwordx4 a[16:19], v2, s[32:35], s47 offen sc1
    v_mfma_f32_32x32x16_bf16 v[64:79], v[28:31], a[72:75], v[64:79]
    s_add_u32 s47, s43, 16384
    buffer_load_dwordx4 a[20:23], v2, s[32:35], s47 offen sc1
    v_mfma_f32_32x32x16_bf16 v[80:95], v[24:27], a[76:79], v[80:95]
    s_add_u32 m0, s40, 4096
    s_add_u32 s46, s41, 262144
    buffer_load_dwordx4 v3, s[36:39], s46 offen lds
    v_mfma_f32_32x32x16_bf16 v[96:111], v[28:31], a[76:79], v[96:111]
    s_add_u32 m0, s40, 5120
    s_add_u32 s46, s41, 270336
    buffer_load_dwordx4 v3, s[36:39], s46 offen lds
    s_waitcnt lgkmcnt(0)
    s_waitcnt vmcnt(20)
    ds_read_b64_tr_b16 v[24:25], v4 offset:22528
    ds_read_b64_tr_b16 v[26:27], v4 offset:23552
    ds_read_b64_tr_b16 v[28:29], v5 offset:22528
    ds_read_b64_tr_b16 v[30:31], v5 offset:23552
    v_mfma_f32_32x32x16_bf16 v[48:63], v[16:19], a[80:83], v[48:63]
    s_add_u32 s47, s42, 17408
    buffer_load_dwordx4 a[24:27], v2, s[32:35], s47 offen sc1
    v_mfma_f32_32x32x16_bf16 v[64:79], v[20:23], a[80:83], v[64:79]
    s_add_u32 s47, s43, 17408
    buffer_load_dwordx4 a[28:31], v2, s[32:35], s47 offen sc1
    v_mfma_f32_32x32x16_bf16 v[80:95], v[16:19], a[84:87], v[80:95]
    s_add_u32 m0, s40, 6144
    s_add_u32 s46, s41, 278528
    buffer_load_dwordx4 v3, s[36:39], s46 offen lds
    v_mfma_f32_32x32x16_bf16 v[96:111], v[20:23], a[84:87], v[96:111]
    s_add_u32 m0, s40, 7168
    s_add_u32 s46, s41, 286720
    buffer_load_dwordx4 v3, s[36:39], s46 offen lds
    s_waitcnt lgkmcnt(0)
    s_waitcnt vmcnt(20)
    ds_read_b64_tr_b16 v[16:17], v4 offset:24576
    ds_read_b64_tr_b16 v[18:19], v4 offset:25600
    ds_read_b64_tr_b16 v[20:21], v5 offset:24576
    ds_read_b64_tr_b16 v[22:23], v5 offset:25600
    v_mfma_f32_32x32x16_bf16 v[48:63], v[24:27], a[88:91], v[48:63]
    s_add_u32 s47, s42, 18432
    buffer_load_dwordx4 a[32:35], v2, s[32:35], s47 offen sc1
    v_mfma_f32_32x32x16_bf16 v[64:79], v[28:31], a[88:91], v[64:79]
    s_add_u32 s47, s43, 18432
    buffer_load_dwordx4 a[36:39], v2, s[32:35], s47 offen sc1
    v_mfma_f32_32x32x16_bf16 v[80:95], v[24:27], a[92:95], v[80:95]
    s_add_u32 m0, s40, 8192
    s_add_u32 s46, s41, 294912
    buffer_load_dwordx4 v3, s[36:39], s46 offen lds
    v_mfma_f32_32x32x16_bf16 v[96:111], v[28:31], a[92:95], v[96:111]
    s_add_u32 m0, s40, 9216
    s_add_u32 s46, s41, 303104
    buffer_load_dwordx4 v3, s[36:39], s46 offen lds
    s_waitcnt lgkmcnt(0)
    s_waitcnt vmcnt(20)
    ds_read_b64_tr_b16 v[24:25], v4 offset:26624
    ds_read_b64_tr_b16 v[26:27], v4 offset:27648
    ds_read_b64_tr_b16 v[28:29], v5 offset:26624
    ds_read_b64_tr_b16 v[30:31], v5 offset:27648
    v_mfma_f32_32x32x16_bf16 v[48:63], v[16:19], a[96:99], v[48:63]
    s_add_u32 s47, s42, 19456
    buffer_load_dwordx4 a[40:43], v2, s[32:35], s47 offen sc1
    v_mfma_f32_32x32x16_bf16 v[64:79], v[20:23], a[96:99], v[64:79]
    s_add_u32 s47, s43, 19456
    buffer_load_dwordx4 a[44:47], v2, s[32:35], s47 offen sc1
    v_mfma_f32_32x32x16_bf16 v[80:95], v[16:19], a[100:103], v[80:95]
    s_add_u32 m0, s40, 10240
    s_add_u32 s46, s41, 311296
    buffer_load_dwordx4 v3, s[36:39], s46 offen lds
    v_mfma_f32_32x32x16_bf16 v[96:111], v[20:23], a[100:103], v[96:111]
    s_add_u32 m0, s40, 11264
    s_add_u32 s46, s41, 319488
    buffer_load_dwordx4 v3, s[36:39], s46 offen lds
    s_waitcnt lgkmcnt(0)
    s_waitcnt vmcnt(20)
    ds_read_b64_tr_b16 v[16:17], v4 offset:0
    ds_read_b64_tr_b16 v[18:19], v4 offset:1024
    ds_read_b64_tr_b16 v[20:21], v5 offset:0
    ds_read_b64_tr_b16 v[22:23], v5 offset:1024
    v_mfma_f32_32x32x16_bf16 v[48:63], v[24:27], a[104:107], v[48:63]
    s_add_u32 s47, s42, 20480
    buffer_load_dwordx4 a[48:51], v2, s[32:35], s47 offen sc1
    v_mfma_f32_32x32x16_bf16 v[64:79], v[28:31], a[104:107], v[64:79]
    s_add_u32 s47, s43, 20480
    buffer_load_dwordx4 a[52:55], v2, s[32:35], s47 offen sc1
    v_mfma_f32_32x32x16_bf16 v[80:95], v[24:27], a[108:111], v[80:95]
    s_add_u32 m0, s40, 12288
    s_add_u32 s46, s41, 327680
    buffer_load_dwordx4 v3, s[36:39], s46 offen lds
    v_mfma_f32_32x32x16_bf16 v[96:111], v[28:31], a[108:111], v[96:111]
    s_add_u32 m0, s40, 13312
    s_add_u32 s46, s41, 335872
    buffer_load_dwordx4 v3, s[36:39], s46 offen lds
    s_waitcnt lgkmcnt(0)
    s_waitcnt vmcnt(20)
    ds_read_b64_tr_b16 v[24:25], v4 offset:2048
    ds_read_b64_tr_b16 v[26:27], v4 offset:3072
    ds_read_b64_tr_b16 v[28:29], v5 offset:2048
    ds_read_b64_tr_b16 v[30:31], v5 offset:3072
    v_mfma_f32_32x32x16_bf16 v[48:63], v[16:19], a[0:3], v[48:63]
    s_add_u32 s47, s42, 21504
    buffer_load_dwordx4 a[56:59], v2, s[32:35], s47 offen sc1
    v_mfma_f32_32x32x16_bf16 v[64:79], v[20:23], a[0:3], v[64:79]
    s_add_u32 s47, s43, 21504
    buffer_load_dwordx4 a[60:63], v2, s[32:35], s47 offen sc1
    v_mfma_f32_32x32x16_bf16 v[80:95], v[16:19], a[4:7], v[80:95]
    s_add_u32 m0, s40, 14336
    s_add_u32 s46, s41, 344064
    buffer_load_dwordx4 v3, s[36:39], s46 offen lds
    v_mfma_f32_32x32x16_bf16 v[96:111], v[20:23], a[4:7], v[96:111]
    s_add_u32 m0, s40, 15360
    s_add_u32 s46, s41, 352256
    buffer_load_dwordx4 v3, s[36:39], s46 offen lds
    s_waitcnt lgkmcnt(0)
    s_waitcnt vmcnt(20)
    ds_read_b64_tr_b16 v[16:17], v4 offset:4096
    ds_read_b64_tr_b16 v[18:19], v4 offset:5120
    ds_read_b64_tr_b16 v[20:21], v5 offset:4096
    ds_read_b64_tr_b16 v[22:23], v5 offset:5120
    v_mfma_f32_32x32x16_bf16 v[48:63], v[24:27], a[8:11], v[48:63]
    s_add_u32 s47, s42, 22528
    buffer_load_dwordx4 a[64:67], v2, s[32:35], s47 offen sc1
    v_mfma_f32_32x32x16_bf16 v[64:79], v[28:31], a[8:11], v[64:79]
    s_add_u32 s47, s43, 22528
    buffer_load_dwordx4 a[68:71], v2, s[32:35], s47 offen sc1
    v_mfma_f32_32x32x16_bf16 v[80:95], v[24:27], a[12:15], v[80:95]
    s_add_u32 m0, s40, 16384
    s_add_u32 s46, s41, 360448
    buffer_load_dwordx4 v3, s[36:39], s46 offen lds
    v_mfma_f32_32x32x16_bf16 v[96:111], v[28:31], a[12:15], v[96:111]
    s_add_u32 m0, s40, 17408
    s_add_u32 s46, s41, 368640
    buffer_load_dwordx4 v3, s[36:39], s46 offen lds
    s_waitcnt lgkmcnt(0)
    s_waitcnt vmcnt(20)
    ds_read_b64_tr_b16 v[24:25], v4 offset:6144
    ds_read_b64_tr_b16 v[26:27], v4 offset:7168
    ds_read_b64_tr_b16 v[28:29], v5 offset:6144
    ds_read_b64_tr_b16 v[30:31], v5 offset:7168
    v_mfma_f32_32x32x16_bf16 v[48:63], v[16:19], a[16:19], v[48:63]
    s_add_u32 s47, s42, 23552
    buffer_load_dwordx4 a[72:75], v2, s[32:35], s47 offen sc1
    v_mfma_f32_32x32x16_bf16 v[64:79], v[20:23], a[16:19], v[64:79]
    s_add_u32 s47, s43, 23552
    buffer_load_dwordx4 a[76:79], v2, s[32:35], s47 offen sc1
    v_mfma_f32_32x32x16_bf16 v[80:95], v[16:19], a[20:23], v[80:95]
    s_add_u32 m0, s40, 18432
    s_add_u32 s46, s41, 376832
    buffer_load_dwordx4 v3, s[36:39], s46 offen lds
    v_mfma_f32_32x32x16_bf16 v[96:111], v[20:23], a[20:23], v[96:111]
    s_add_u32 m0, s40, 19456
    s_add_u32 s46, s41, 385024
    buffer_load_dwordx4 v3, s[36:39], s46 offen lds
    s_waitcnt lgkmcnt(0)
    s_waitcnt vmcnt(20)
    ds_read_b64_tr_b16 v[16:17], v4 offset:8192
    ds_read_b64_tr_b16 v[18:19], v4 offset:9216
    ds_read_b64_tr_b16 v[20:21], v5 offset:8192
    ds_read_b64_tr_b16 v[22:23], v5 offset:9216
    v_mfma_f32_32x32x16_bf16 v[48:63], v[24:27], a[24:27], v[48:63]
    s_add_u32 s47, s42, 24576
    buffer_load_dwordx4 a[80:83], v2, s[32:35], s47 offen sc1
    v_mfma_f32_32x32x16_bf16 v[64:79], v[28:31], a[24:27], v[64:79]
    s_add_u32 s47, s43, 24576
    buffer_load_dwordx4 a[84:87], v2, s[32:35], s47 offen sc1
    v_mfma_f32_32x32x16_bf16 v[80:95], v[24:27], a[28:31], v[80:95]
    s_add_u32 m0, s40, 20480
    s_add_u32 s46, s41, 393216
    buffer_load_dwordx4 v3, s[36:39], s46 offen lds
    v_mfma_f32_32x32x16_bf16 v[96:111], v[28:31], a[28:31], v[96:111]
    s_add_u32 m0, s40, 21504
    s_add_u32 s46, s41, 401408
    buffer_load_dwordx4 v3, s[36:39], s46 offen lds
    s_waitcnt lgkmcnt(0)
    s_waitcnt vmcnt(20)
    ds_read_b64_tr_b16 v[24:25], v4 offset:10240
    ds_read_b64_tr_b16 v[26:27], v4 offset:11264
    ds_read_b64_tr_b16 v[28:29], v5 offset:10240
    ds_read_b64_tr_b16 v[30:31], v5 offset:11264
    v_mfma_f32_32x32x16_bf16 v[48:63], v[16:19], a[32:35], v[48:63]
    s_add_u32 s47, s42, 25600
    buffer_load_dwordx4 a[88:91], v2, s[32:35], s47 offen sc1
    v_mfma_f32_32x32x16_bf16 v[64:79], v[20:23], a[32:35], v[64:79]
    s_add_u32 s47, s43, 25600
    buffer_load_dwordx4 a[92:95], v2, s[32:35], s47 offen sc1
    v_mfma_f32_32x32x16_bf16 v[80:95], v[16:19], a[36:39], v[80:95]
    s_add_u32 m0, s40, 22528
    s_add_u32 s46, s41, 409600
    buffer_load_dwordx4 v3, s[36:39], s46 offen lds
    v_mfma_f32_32x32x16_bf16 v[96:111], v[20:23], a[36:39], v[96:111]
    s_add_u32 m0, s40, 23552
    s_add_u32 s46, s41, 417792
    buffer_load_dwordx4 v3, s[36:39], s46 offen lds
    s_waitcnt lgkmcnt(0)
    s_waitcnt vmcnt(20)
    ds_read_b64_tr_b16 v[16:17], v4 offset:12288
    ds_read_b64_tr_b16 v[18:19], v4 offset:13312
    ds_read_b64_tr_b16 v[20:21], v5 offset:12288
    ds_read_b64_tr_b16 v[22:23], v5 offset:13312
    v_mfma_f32_32x32x16_bf16 v[48:63], v[24:27], a[40:43], v[48:63]
    s_add_u32 s47, s42, 26624
    buffer_load_dwordx4 a[96:99], v2, s[32:35], s47 offen sc1
    v_mfma_f32_32x32x16_bf16 v[64:79], v[28:31], a[40:43], v[64:79]
    s_add_u32 s47, s43, 26624
    buffer_load_dwordx4 a[100:103], v2, s[32:35], s47 offen sc1
    v_mfma_f32_32x32x16_bf16 v[80:95], v[24:27], a[44:47], v[80:95]
    s_add_u32 m0, s40, 24576
    s_add_u32 s46, s41, 425984
    buffer_load_dwordx4 v3, s[36:39], s46 offen lds
    v_mfma_f32_32x32x16_bf16 v[96:111], v[28:31], a[44:47], v[96:111]
    s_add_u32 m0, s40, 25600
    s_add_u32 s46, s41, 434176
    buffer_load_dwordx4 v3, s[36:39], s46 offen lds
    s_waitcnt lgkmcnt(0)
    s_waitcnt vmcnt(20)
    ds_read_b64_tr_b16 v[24:25], v4 offset:14336
    ds_read_b64_tr_b16 v[26:27], v4 offset:15360
    ds_read_b64_tr_b16 v[28:29], v5 offset:14336
    ds_read_b64_tr_b16 v[30:31], v5 offset:15360
    v_mfma_f32_32x32x16_bf16 v[48:63], v[16:19], a[48:51], v[48:63]
    s_add_u32 s47, s42, 27648
    buffer_load_dwordx4 a[104:107], v2, s[32:35], s47 offen sc1
    v_mfma_f32_32x32x16_bf16 v[64:79], v[20:23], a[48:51], v[64:79]
    s_add_u32 s47, s43, 27648
    buffer_load_dwordx4 a[108:111], v2, s[32:35], s47 offen sc1
    v_mfma_f32_32x32x16_bf16 v[80:95], v[16:19], a[52:55], v[80:95]
    s_add_u32 m0, s40, 26624
    s_add_u32 s46, s41, 442368
    buffer_load_dwordx4 v3, s[36:39], s46 offen lds
    v_mfma_f32_32x32x16_bf16 v[96:111], v[20:23], a[52:55], v[96:111]
    s_add_u32 m0, s40, 27648
    s_add_u32 s46, s41, 450560
    buffer_load_dwordx4 v3, s[36:39], s46 offen lds
    s_waitcnt lgkmcnt(0)
    s_waitcnt vmcnt(20)
    ds_read_b64_tr_b16 v[16:17], v4 offset:16384
    ds_read_b64_tr_b16 v[18:19], v4 offset:17408
    ds_read_b64_tr_b16 v[20:21], v5 offset:16384
    ds_read_b64_tr_b16 v[22:23], v5 offset:17408
    v_mfma_f32_32x32x16_bf16 v[48:63], v[24:27], a[56:59], v[48:63]
    v_mfma_f32_32x32x16_bf16 v[64:79], v[28:31], a[56:59], v[64:79]
    buffer_load_dwordx4 v[120:123], v9, s[32:35], s52 offen sc1
    v_mfma_f32_32x32x16_bf16 v[80:95], v[24:27], a[60:63], v[80:95]
    v_mfma_f32_32x32x16_bf16 v[96:111], v[28:31], a[60:63], v[96:111]
    buffer_load_dwordx4 v[124:127], v9, s[32:35], s52 offen offset:16 sc1
    s_waitcnt lgkmcnt(0)
    s_waitcnt vmcnt(18)
    ds_read_b64_tr_b16 v[24:25], v4 offset:18432
    ds_read_b64_tr_b16 v[26:27], v4 offset:19456
    ds_read_b64_tr_b16 v[28:29], v5 offset:18432
    ds_read_b64_tr_b16 v[30:31], v5 offset:19456
    v_mfma_f32_32x32x16_bf16 v[48:63], v[16:19], a[64:67], v[48:63]
    v_mfma_f32_32x32x16_bf16 v[64:79], v[20:23], a[64:67], v[64:79]
    v_mfma_f32_32x32x16_bf16 v[80:95], v[16:19], a[68:71], v[80:95]
    v_mfma_f32_32x32x16_bf16 v[96:111], v[20:23], a[68:71], v[96:111]
    s_waitcnt lgkmcnt(0)
    s_waitcnt vmcnt(14)
    ds_read_b64_tr_b16 v[16:17], v4 offset:20480
    ds_read_b64_tr_b16 v[18:19], v4 offset:21504
    ds_read_b64_tr_b16 v[20:21], v5 offset:20480
    ds_read_b64_tr_b16 v[22:23], v5 offset:21504
    v_mfma_f32_32x32x16_bf16 v[48:63], v[24:27], a[72:75], v[48:63]
    v_mfma_f32_32x32x16_bf16 v[64:79], v[28:31], a[72:75], v[64:79]
    v_mfma_f32_32x32x16_bf16 v[80:95], v[24:27], a[76:79], v[80:95]
    v_mfma_f32_32x32x16_bf16 v[96:111], v[28:31], a[76:79], v[96:111]
    s_waitcnt lgkmcnt(0)
    s_waitcnt vmcnt(10)
    ds_read_b64_tr_b16 v[24:25], v4 offset:22528
    ds_read_b64_tr_b16 v[26:27], v4 offset:23552
    ds_read_b64_tr_b16 v[28:29], v5 offset:22528
    ds_read_b64_tr_b16 v[30:31], v5 offset:23552
    v_mfma_f32_32x32x16_bf16 v[48:63], v[16:19], a[80:83], v[48:63]
    v_mfma_f32_32x32x16_bf16 v[64:79], v[20:23], a[80:83], v[64:79]
    v_mfma_f32_32x32x16_bf16 v[80:95], v[16:19], a[84:87], v[80:95]
    v_mfma_f32_32x32x16_bf16 v[96:111], v[20:23], a[84:87], v[96:111]
    s_waitcnt lgkmcnt(0)
    s_waitcnt vmcnt(6)
    ds_read_b64_tr_b16 v[16:17], v4 offset:24576
    ds_read_b64_tr_b16 v[18:19], v4 offset:25600
    ds_read_b64_tr_b16 v[20:21], v5 offset:24576
    ds_read_b64_tr_b16 v[22:23], v5 offset:25600
    v_mfma_f32_32x32x16_bf16 v[48:63], v[24:27], a[88:91], v[48:63]
    v_mfma_f32_32x32x16_bf16 v[64:79], v[28:31], a[88:91], v[64:79]
    v_mfma_f32_32x32x16_bf16 v[80:95], v[24:27], a[92:95], v[80:95]
    v_mfma_f32_32x32x16_bf16 v[96:111], v[28:31], a[92:95], v[96:111]
    s_waitcnt lgkmcnt(0)
    s_waitcnt vmcnt(2)
    ds_read_b64_tr_b16 v[24:25], v4 offset:26624
    ds_read_b64_tr_b16 v[26:27], v4 offset:27648
    ds_read_b64_tr_b16 v[28:29], v5 offset:26624
    ds_read_b64_tr_b16 v[30:31], v5 offset:27648
    v_mfma_f32_32x32x16_bf16 v[48:63], v[16:19], a[96:99], v[48:63]
    v_mfma_f32_32x32x16_bf16 v[64:79], v[20:23], a[96:99], v[64:79]
    v_mfma_f32_32x32x16_bf16 v[80:95], v[16:19], a[100:103], v[80:95]
    v_mfma_f32_32x32x16_bf16 v[96:111], v[20:23], a[100:103], v[96:111]
    s_waitcnt lgkmcnt(0)
    v_mfma_f32_32x32x16_bf16 v[48:63], v[24:27], a[104:107], v[48:63]
    v_mfma_f32_32x32x16_bf16 v[64:79], v[28:31], a[104:107], v[64:79]
    v_mfma_f32_32x32x16_bf16 v[80:95], v[24:27], a[108:111], v[80:95]
    v_mfma_f32_32x32x16_bf16 v[96:111], v[28:31], a[108:111], v[96:111]
    s_barrier
    v_and_b32 v11, 31, v1
    v_mul_u32_u24 v11, 272, v11
    v_lshrrev_b32 v12, 5, v1
    v_lshl_add_u32 v11, v12, 4, v11
    s_mul_i32 s40, s30, 17408
    v_add_u32 v11, s40, v11
    s_nop 1
    ds_write_b128 v11, v[48:51] offset:0
    ds_write_b128 v11, v[52:55] offset:32
    ds_write_b128 v11, v[56:59] offset:64
    ds_write_b128 v11, v[60:63] offset:96
    ds_write_b128 v11, v[64:67] offset:128
    ds_write_b128 v11, v[68:71] offset:160
    ds_write_b128 v11, v[72:75] offset:192
    ds_write_b128 v11, v[76:79] offset:224
    ds_write_b128 v11, v[80:83] offset:8704
    ds_write_b128 v11, v[84:87] offset:8736
    ds_write_b128 v11, v[88:91] offset:8768
    ds_write_b128 v11, v[92:95] offset:8800
    ds_write_b128 v11, v[96:99] offset:8832
    ds_write_b128 v11, v[100:103] offset:8864
    ds_write_b128 v11, v[104:107] offset:8896
    ds_write_b128 v11, v[108:111] offset:8928
    s_lshl_b32 s42, s44, 16
    s_lshl_b32 s43, s45, 7
    s_add_u32 s42, s42, s43
    s_add_u32 s43, s42, 32768
    v_accvgpr_read_b32 v112, a248
    v_accvgpr_read_b32 v113, a249
    v_accvgpr_read_b32 v114, a250
    v_accvgpr_read_b32 v115, a251
    v_accvgpr_read_b32 v116, a252
    v_accvgpr_read_b32 v117, a253
    v_accvgpr_read_b32 v118, a254
    v_accvgpr_read_b32 v119, a255
    s_waitcnt lgkmcnt(0)
    s_barrier
    v_and_b32 v11, 31, v1
    v_mul_u32_u24 v11, 272, v11
    v_lshrrev_b32 v12, 5, v1
    v_lshl_add_u32 v11, v12, 5, v11
    s_lshl_b32 s55, s30, 6
    v_add_u32 v11, s55, v11
    ds_read_b128 v[136:139], v11 offset:0
    ds_read_b128 v[140:143], v11 offset:16
    ds_read_b128 v[144:147], v11 offset:8704
    ds_read_b128 v[148:151], v11 offset:8720
    ds_read_b128 v[152:155], v11 offset:17408
    ds_read_b128 v[156:159], v11 offset:17424
    ds_read_b128 v[160:163], v11 offset:26112
    ds_read_b128 v[164:167], v11 offset:26128
    ds_read_b128 v[168:171], v11 offset:34816
    ds_read_b128 v[172:175], v11 offset:34832
    ds_read_b128 v[176:179], v11 offset:43520
    ds_read_b128 v[180:183], v11 offset:43536
    ds_read_b128 v[184:187], v11 offset:52224
    ds_read_b128 v[188:191], v11 offset:52240
    ds_read_b128 v[192:195], v11 offset:60928
    ds_read_b128 v[196:199], v11 offset:60944
    s_waitcnt lgkmcnt(8)
    v_pk_add_f32 v[136:137], v[136:137], v[152:153]
    v_pk_add_f32 v[138:139], v[138:139], v[154:155]
    v_pk_add_f32 v[140:141], v[140:141], v[156:157]
    v_pk_add_f32 v[142:143], v[142:143], v[158:159]
    v_pk_add_f32 v[144:145], v[144:145], v[160:161]
    v_pk_add_f32 v[146:147], v[146:147], v[162:163]
    v_pk_add_f32 v[148:149], v[148:149], v[164:165]
    v_pk_add_f32 v[150:151], v[150:151], v[166:167]
    s_waitcnt lgkmcnt(0)
    v_pk_add_f32 v[168:169], v[168:169], v[184:185]
    v_pk_add_f32 v[170:171], v[170:171], v[186:187]
    v_pk_add_f32 v[172:173], v[172:173], v[188:189]
    v_pk_add_f32 v[174:175], v[174:175], v[190:191]
    v_pk_add_f32 v[176:177], v[176:177], v[192:193]
    v_pk_add_f32 v[178:179], v[178:179], v[194:195]
    v_pk_add_f32 v[180:181], v[180:181], v[196:197]
    v_pk_add_f32 v[182:183], v[182:183], v[198:199]
    v_pk_add_f32 v[136:137], v[136:137], v[168:169]
    v_pk_add_f32 v[138:139], v[138:139], v[170:171]
    v_pk_add_f32 v[140:141], v[140:141], v[172:173]
    v_pk_add_f32 v[142:143], v[142:143], v[174:175]
    v_pk_add_f32 v[144:145], v[144:145], v[176:177]
    v_pk_add_f32 v[146:147], v[146:147], v[178:179]
    v_pk_add_f32 v[148:149], v[148:149], v[180:181]
    v_pk_add_f32 v[150:151], v[150:151], v[182:183]
    s_waitcnt vmcnt(0)
    v_lshlrev_b32 v48, 16, v112
    v_and_b32 v49, 0xffff0000, v112
    v_lshlrev_b32 v50, 16, v113
    v_and_b32 v51, 0xffff0000, v113
    v_lshlrev_b32 v52, 16, v114
    v_and_b32 v53, 0xffff0000, v114
    v_lshlrev_b32 v54, 16, v115
    v_and_b32 v55, 0xffff0000, v115
    v_pk_fma_f32 v[48:49], v[120:121], v[136:137], v[48:49]
    v_pk_fma_f32 v[50:51], v[122:123], v[138:139], v[50:51]
    v_pk_fma_f32 v[52:53], v[124:125], v[140:141], v[52:53]
    v_pk_fma_f32 v[54:55], v[126:127], v[142:143], v[54:55]
    v_cvt_pk_bf16_f32 v64, v48, v49
    v_cvt_pk_bf16_f32 v65, v50, v51
    v_cvt_pk_bf16_f32 v66, v52, v53
    v_cvt_pk_bf16_f32 v67, v54, v55
    buffer_store_dwordx4 v[64:67], v8, s[48:51], s42 offen
    v_lshlrev_b32 v56, 16, v116
    v_and_b32 v57, 0xffff0000, v116
    v_lshlrev_b32 v58, 16, v117
    v_and_b32 v59, 0xffff0000, v117
    v_lshlrev_b32 v60, 16, v118
    v_and_b32 v61, 0xffff0000, v118
    v_lshlrev_b32 v62, 16, v119
    v_and_b32 v63, 0xffff0000, v119
    v_pk_fma_f32 v[56:57], v[120:121], v[144:145], v[56:57]
    v_pk_fma_f32 v[58:59], v[122:123], v[146:147], v[58:59]
    v_pk_fma_f32 v[60:61], v[124:125], v[148:149], v[60:61]
    v_pk_fma_f32 v[62:63], v[126:127], v[150:151], v[62:63]
    v_cvt_pk_bf16_f32 v68, v56, v57
    v_cvt_pk_bf16_f32 v69, v58, v59
    v_cvt_pk_bf16_f32 v70, v60, v61
    v_cvt_pk_bf16_f32 v71, v62, v63
    buffer_store_dwordx4 v[68:71], v8, s[48:51], s43 offen
adaLN_cond__linear_kernel_hedgehog__glu_gated_reglu__prompt_kernel_end:
    s_endpgm

code_end:
    s_endpgm
.section .rodata,"a"
.p2align 6
.amdhsa_kernel adaLN_cond__linear_kernel_hedgehog__glu_gated_reglu__prompt_kernel
  .amdhsa_next_free_vgpr 512
  .amdhsa_next_free_sgpr 100
  .amdhsa_accum_offset 256
  .amdhsa_group_segment_fixed_size 0
  .amdhsa_kernarg_size 104
  .amdhsa_user_sgpr_count 2
  .amdhsa_user_sgpr_kernarg_segment_ptr 1
  .amdhsa_system_sgpr_workgroup_id_x 1
  .amdhsa_float_denorm_mode_32 3
.end_amdhsa_kernel
```
